```python
import torch

def _softmax(x, axis=-1):
    return torch.softmax(x, dim=axis)
def _gelu(x):
    return torch.nn.functional.gelu(x, approximate="tanh")
def _silu(x):
    return torch.nn.functional.silu(x)
def _sigmoid(x):
    return torch.sigmoid(x)
def _layernorm(x, axis=-1, eps=1e-5):
    m = x.mean(dim=axis, keepdim=True)
    v = x.var(dim=axis, keepdim=True, unbiased=False)
    return (x - m) / torch.sqrt(v + eps)
def _scatter_add(tgt, idx, src, axis=0):
    return tgt.clone().index_add_(axis, idx, src)
def _segment_sum(src, seg, n):
    out = torch.zeros((n,) + src.shape[1:], dtype=src.dtype)
    return out.index_add_(0, seg, src)
def _pad(x, pw):
    flat = tuple(v for pair in reversed(pw) for v in pair)
    return torch.nn.functional.pad(x, flat)

kernel_name = 'gated_mix__sliding_block__mha_block__prompt'

def setup_inputs():

    _w = (lambda a: (lambda t: t.to(torch.bfloat16) if t.is_floating_point() else t)(torch.as_tensor(a)))
    def _A_setup():
        B, S, D = 1, 2048, 1024
        return {
            "x": _w((lambda *s: torch.randn(*s, dtype=torch.bfloat16) * 0.05)(B, S, D)),
            "wqkv": _w((lambda *s: torch.randn(*s, dtype=torch.bfloat16) * 0.8)(D, 3 * D)),
            "wo": _w((lambda *s: torch.randn(*s, dtype=torch.bfloat16) * 0.05)(D, D)),
        }
    _A_in = _A_setup()

    def _B_setup():
        B, S, D, H = 1, 2048, 1024, 32
        return {
            "x": _w((lambda *s: torch.randn(*s, dtype=torch.bfloat16) * 0.05)(B, S, D)),
            "wqkv": _w((lambda *s: torch.randn(*s, dtype=torch.bfloat16) * 0.8)(D, 3 * D)),
            "wo": _w((lambda *s: torch.randn(*s, dtype=torch.bfloat16) * 0.1)(D, D)),
        }
    _B_in = _B_setup()

    return {
        "A_x": _A_in["x"],
        "A_wqkv": _A_in["wqkv"],
        "A_wo": _A_in["wo"],
        "B_x": _B_in["x"],
        "B_wqkv": _B_in["wqkv"],
        "B_wo": _B_in["wo"],
        "gate_w": _w((lambda *s: torch.randn(*s, dtype=torch.bfloat16) * 0.05)(1024) * 16.0),
    }

def reference(A_x, A_wqkv, A_wo, B_x, B_wqkv, B_wo, gate_w):
    def _A_ref(x, wqkv, wo):
        B, S, D = x.shape
        H = 32; Dh = D // H; W = 256
        qkv = (lambda x, *d: x.permute(*d))((x @ wqkv).reshape(B, S, 3, H, Dh), 2, 0, 3, 1, 4)
        q, k, v = qkv[0], qkv[1], qkv[2]
        scores = torch.einsum("bhqd,bhkd->bhqk", q, k) * (Dh ** -0.5)
        idx = torch.arange(S)
        mask = (idx[:, None] - idx[None, :] >= 0) & (idx[:, None] - idx[None, :] < W)
        scores = torch.where(mask[None, None], scores, -1e9)
        p = _softmax(scores, axis=-1)
        o = torch.einsum("bhqk,bhkd->bhqd", p, v)
        return (lambda x, *d: x.permute(*d))(o, 0, 2, 1, 3).reshape(B, S, D) @ wo

    def _B_ref(x, wqkv, wo):
        B, S, D = x.shape
        H = 32
        Dh = D // H
        qkv = (lambda x, *d: x.permute(*d))((x @ wqkv).reshape(B, S, 3, H, Dh), 2, 0, 3, 1, 4)
        q, k, v = qkv[0], qkv[1], qkv[2]
        scores = torch.einsum("bhqd,bhkd->bhqk", q, k) * (Dh ** -0.5)
        p = _softmax(scores, axis=-1)
        o = torch.einsum("bhqk,bhkd->bhqd", p, v)
        return (lambda x, *d: x.permute(*d))(o, 0, 2, 1, 3).reshape(B, S, D) @ wo

    x = A_x
    g = _sigmoid((x * gate_w).sum(-1, keepdims=True))
    a = _A_ref(x, A_wqkv, A_wo)
    b = _B_ref(x, B_wqkv, B_wo)
    return g * a + (1 - g) * b
```

```asm
; @launch grid=(256,1,1) block=(512,1,1) lds=163840
.amdgcn_target "amdgcn-amd-amdhsa--gfx950"
.text
.globl gated_mix__sliding_block__mha_block__prompt_kernel
.p2align 8
.type gated_mix__sliding_block__mha_block__prompt_kernel,@function
gated_mix__sliding_block__mha_block__prompt_kernel:
    s_cmp_ge_u32 s2, 256
    s_cbranch_scc1 L_end
    s_load_dwordx4 s[4:7], s[0:1], 0
    s_load_dwordx2 s[8:9], s[0:1], 32
    s_load_dwordx2 s[10:11], s[0:1], 48
    s_load_dwordx4 s[12:15], s[0:1], 64
    v_lshrrev_b32 v2, 6, v0
    v_and_b32 v1, 63, v0
    v_readfirstlane_b32 s3, v2
    s_and_b32 s93, s2, 7
    s_lshr_b32 s94, s2, 3
    s_and_b32 s32, s93, 1
    s_lshl_b32 s32, s32, 2
    s_and_b32 s33, s94, 3
    s_add_u32 s32, s32, s33
    s_lshr_b32 s66, s2, 5
    s_lshr_b32 s35, s93, 1
    s_lshl_b32 s35, s35, 2
    s_and_b32 s33, s66, 3
    s_add_u32 s35, s35, s33
    s_lshr_b32 s34, s66, 2
    s_lshl_b32 s33, s34, 4
    s_add_u32 s33, s33, s35
    s_and_b32 s37, s3, 3
    s_lshr_b32 s38, s3, 2
    s_lshl_b32 s44, s3, 12
    s_lshl_b32 s45, s3, 10
    v_lshrrev_b32 v2, 3, v1
    v_and_b32 v3, 7, v1
    v_lshrrev_b32 v4, 1, v2
    v_xor_b32 v5, v3, v4
    s_and_b32 s93, s3, 1
    s_lshl_b32 s93, s93, 2
    v_xor_b32 v5, s93, v5
    s_lshl_b32 s93, s3, 3
    v_add_u32 v6, s93, v2
    v_lshlrev_b32 v6, 11, v6
    v_lshl_add_u32 v6, v5, 4, v6
    v_and_b32 v4, 1, v4
    s_and_b32 s93, s3, 1
    s_lshl_b32 s93, s93, 1
    v_or_b32 v4, s93, v4
    v_lshlrev_b32 v4, 1, v4
    v_xor_b32 v5, v3, v4
    s_lshl_b32 s93, s3, 3
    v_add_u32 v7, s93, v2
    v_mul_u32_u24 v7, 6144, v7
    v_lshl_add_u32 v7, v5, 4, v7
    s_bfe_u32 s93, s2, 0x20001
    s_mul_i32 s93, s93, 4
    s_and_b32 s94, s2, 1
    s_mul_i32 s94, s94, 0
    s_add_u32 s93, s93, s94
    s_and_b32 s93, s93, 15
    s_lshl_b32 s41, s93, 7
    s_mul_i32 s42, s93, 393216
    s_mov_b32 s57, 0
    s_mov_b32 s58, 0
    s_add_u32 s93, s35, 1
    s_and_b32 s93, s93, 15
    s_lshl_b32 s62, s93, 1
    s_add_u32 s62, s62, s38
    s_lshl_b32 s59, s93, 7
    s_add_u32 s93, s35, 0
    s_and_b32 s93, s93, 15
    s_lshl_b32 s63, s93, 1
    s_add_u32 s63, s63, s38
    s_lshl_b32 s60, s93, 7
    s_add_u32 s60, s60, 2048
    s_add_u32 s93, s35, 0
    s_and_b32 s93, s93, 15
    s_lshl_b32 s64, s93, 1
    s_add_u32 s64, s64, s38
    s_lshl_b32 s61, s93, 7
    s_add_u32 s61, s61, 4096
    s_mov_b32 s53, s45
    s_mov_b32 s67, 0
    s_lshl_b32 s36, s37, 13
    s_add_u32 s36, s36, 24576
    s_cmp_eq_u32 s38, 0
    s_cselect_b32 s65, 13, 99
    s_mov_b32 s55, 32768
    s_mov_b32 s56, 0xffff0000
    s_lshl_b32 s93, s32, 19
    s_mov_b32 s18, 524288
    s_mov_b32 s19, 0x00020000
    s_mov_b32 s22, 6291456
    s_mov_b32 s23, 0x00020000
    s_waitcnt lgkmcnt(0)
    s_add_u32 s16, s4, s93
    s_addc_u32 s17, s5, 0
    s_cmp_eq_u32 s34, 0
    s_cselect_b32 s20, s6, s8
    s_cselect_b32 s21, s7, s9
    s_mov_b32 m0, s53
    s_add_u32 s93, s42, s59
    buffer_load_dwordx4 v7, s[20:23], s93 offen lds
    s_add_u32 s53, s53, 8192
    s_cmp_ge_u32 s53, 163840
    s_cselect_b32 s53, s45, s53
    s_mov_b32 m0, s53
    s_add_u32 s93, s42, s60
    buffer_load_dwordx4 v7, s[20:23], s93 offen lds
    s_add_u32 s53, s53, 8192
    s_cmp_ge_u32 s53, 163840
    s_cselect_b32 s53, s45, s53
    s_mov_b32 m0, s53
    s_add_u32 s93, s42, s61
    buffer_load_dwordx4 v7, s[20:23], s93 offen lds
    s_add_u32 s53, s53, 8192
    s_cmp_ge_u32 s53, 163840
    s_cselect_b32 s53, s45, s53
    s_add_u32 s42, s42, 393216
    s_cmp_ge_u32 s42, 6291456
    s_cselect_b32 s42, 0, s42
    s_add_u32 s58, s58, 1
    s_cmp_ge_u32 s58, 16
    s_cselect_b32 s22, 0, 6291456
    s_mov_b32 m0, s53
    s_add_u32 s93, s41, 0
    buffer_load_dwordx4 v6, s[16:19], s93 offen lds
    s_add_u32 s53, s53, 8192
    s_cmp_ge_u32 s53, 163840
    s_cselect_b32 s53, s45, s53
    s_mov_b32 m0, s53
    s_add_u32 s93, s41, 131072
    buffer_load_dwordx4 v6, s[16:19], s93 offen lds
    s_add_u32 s53, s53, 8192
    s_cmp_ge_u32 s53, 163840
    s_cselect_b32 s53, s45, s53
    s_mov_b32 m0, s53
    s_add_u32 s93, s41, 262144
    buffer_load_dwordx4 v6, s[16:19], s93 offen lds
    s_add_u32 s53, s53, 8192
    s_cmp_ge_u32 s53, 163840
    s_cselect_b32 s53, s45, s53
    s_mov_b32 m0, s53
    s_add_u32 s93, s41, 393216
    buffer_load_dwordx4 v6, s[16:19], s93 offen lds
    s_add_u32 s53, s53, 8192
    s_cmp_ge_u32 s53, 163840
    s_cselect_b32 s53, s45, s53
    s_add_u32 s41, s41, 128
    s_and_b32 s41, s41, 2047
    s_add_u32 s57, s57, 1
    s_cmp_ge_u32 s57, 16
    s_cselect_b32 s18, 0, 524288
    v_and_b32 v2, 1, v1
    s_and_b32 s93, s32, 3
    s_lshl_b32 s93, s93, 4
    s_lshl_b32 s94, s3, 1
    s_add_u32 s93, s93, s94
    v_add_u32 v2, s93, v2
    v_mul_u32_u24 v19, 6144, v2
    v_and_b32 v3, 6, v1
    v_mov_b32 v4, s59
    v_mov_b32 v5, s60
    v_cmp_eq_u32 vcc, 2, v3
    s_nop 1
    v_cndmask_b32 v4, v4, v5, vcc
    v_mov_b32 v5, s61
    v_cmp_eq_u32 vcc, 4, v3
    s_nop 1
    v_cndmask_b32 v4, v4, v5, vcc
    v_add_u32 v19, v19, v4
    s_lshl_b32 s93, s66, 5
    s_lshl_b32 s94, s3, 2
    s_add_u32 s93, s93, s94
    v_and_b32 v3, 3, v1
    v_add_u32 v3, s93, v3
    v_lshlrev_b32 v22, 11, v3
    v_lshrrev_b32 v2, 3, v1
    v_min_u32 v2, 1, v2
    s_mov_b32 s93, 393216
    v_mul_lo_u32 v2, v2, s93
    v_add_u32 v2, s42, v2
    v_subrev_u32 v3, 6291456, v2
    v_min_u32 v2, v2, v3
    v_add_u32 v2, v2, v19
    buffer_load_dword v20, v2, s[20:23], 0 offen
    v_lshrrev_b32 v2, 2, v1
    v_min_u32 v2, 1, v2
    v_lshlrev_b32 v2, 7, v2
    v_add_u32 v2, s41, v2
    v_and_b32 v2, 2047, v2
    s_lshl_b32 s93, s66, 5
    s_lshl_b32 s94, s3, 2
    s_add_u32 s93, s93, s94
    v_and_b32 v3, 3, v1
    v_add_u32 v3, s93, v3
    v_lshl_add_u32 v2, v3, 11, v2
    buffer_load_dword v20, v2, s[16:19], 0 offen
    s_mov_b32 s72, s12
    s_mov_b32 s73, s13
    s_mov_b32 s74, 256
    s_mov_b32 s75, 0x00020000
    s_mov_b32 s12, s14
    s_mov_b32 s13, s15
    s_mov_b32 s76, s12
    s_mov_b32 s77, s13
    s_mov_b32 s78, 38797312
    s_mov_b32 s79, 0x00020000
    s_mov_b32 s80, s12
    s_mov_b32 s81, s13
    s_mov_b32 s82, 38797312
    s_mov_b32 s83, 0x00020000
    s_or_b32 s94, s2, s3
    s_cmp_eq_u32 s94, 0
    s_cbranch_scc0 L_nclr
    v_mov_b32 v200, 0
    v_mov_b32 v201, 0
    v_mov_b32 v202, 0
    v_mov_b32 v203, 0
    v_lshlrev_b32 v2, 8, v1
    v_lshrrev_b32 v3, 1, v1
    v_lshlrev_b32 v3, 7, v3
    v_and_b32 v4, 1, v1
    v_lshl_add_u32 v3, v4, 4, v3
    s_mov_b32 s93, 33685504
    s_mov_b32 s94, 33701888
    buffer_store_dword v200, v2, s[76:79], s93 offen sc1
    buffer_store_dwordx4 v[200:203], v3, s[76:79], s94 offen sc1
    buffer_store_dwordx4 v[200:203], v3, s[76:79], s94 offen offset:64 sc1
L_nclr:
    s_cmp_eq_u32 s34, 0
    s_cselect_b32 s78, 0, 38797312
    s_cselect_b32 s82, 38797312, 0
    v_and_b32 v2, 15, v1
    v_lshrrev_b32 v3, 4, v1
    v_lshrrev_b32 v4, 1, v2
    v_xor_b32 v4, v3, v4
    v_lshlrev_b32 v10, 7, v2
    v_lshl_add_u32 v10, v4, 4, v10
    v_lshlrev_b32 v248, 9, v3
    v_lshl_add_u32 v248, v2, 4, v248
    v_lshrrev_b32 v4, 3, v2
    v_lshlrev_b32 v249, 9, v3
    v_lshl_add_u32 v249, v4, 8, v249
    v_and_b32 v4, 7, v2
    v_lshl_add_u32 v249, v4, 4, v249
    v_lshrrev_b32 v4, 2, v2
    v_lshl_add_u32 v5, v3, 3, v4
    v_lshlrev_b32 v11, 7, v5
    v_and_b32 v5, 3, v1
    v_lshl_add_u32 v11, v5, 3, v11
    v_lshrrev_b32 v4, 1, v4
    v_and_b32 v5, 1, v3
    v_lshl_add_u32 v4, v5, 1, v4
    s_lshl_b32 s93, s38, 1
    v_xor_b32 v4, s93, v4
    v_lshl_add_u32 v11, v4, 5, v11
    v_xor_b32 v12, 32, v11
    v_add_u32 v13, s67, v11
    v_add_u32 v14, s67, v12
    s_add_u32 s94, s67, 8192
    s_sub_u32 s55, s94, 163840
    s_min_u32 s94, s94, s55
    v_add_u32 v15, s94, v11
    v_add_u32 v16, s94, v12
    s_add_u32 s94, s67, 16384
    s_sub_u32 s55, s94, 163840
    s_min_u32 s94, s94, s55
    v_add_u32 v17, s94, v11
    v_add_u32 v18, s94, v12
    s_add_u32 s94, s67, s36
    s_sub_u32 s55, s94, 163840
    s_min_u32 s94, s94, s55
    v_add_u32 v8, s94, v10
    v_xor_b32 v9, 64, v8
    s_lshl_b32 s93, s32, 3
    s_lshl_b32 s94, s37, 1
    s_add_u32 s93, s93, s94
    s_lshl_b32 s94, s34, 5
    s_add_u32 s62, s62, s94
    s_add_u32 s63, s63, s94
    s_add_u32 s64, s64, s94
    s_lshl_b32 s84, s62, 6
    s_add_u32 s84, s84, s93
    s_lshl_b32 s84, s84, 11
    s_lshl_b32 s85, s63, 6
    s_add_u32 s85, s85, s93
    s_lshl_b32 s85, s85, 12
    s_add_u32 s85, s85, 8388608
    s_lshl_b32 s87, s64, 6
    s_add_u32 s87, s87, s93
    s_lshl_b32 s87, s87, 12
    s_add_u32 s87, s87, 8388608
    s_add_u32 s86, s85, 4096
    s_add_u32 s88, s87, 4096
    s_lshl_b32 s90, s32, 8
    s_lshl_b32 s94, s33, 3
    s_add_u32 s90, s90, s94
    s_add_u32 s90, s90, s3
    s_lshl_b32 s90, s90, 2
    s_add_u32 s90, s90, 33619968
    s_add_u32 s91, s90, 8192
    s_lshl_b32 s92, s33, 5
    s_add_u32 s92, s92, s32
    s_lshl_b32 s92, s92, 2
    s_add_u32 s92, s92, 33701888
    s_waitcnt vmcnt(2)
    s_barrier
    ds_read_b64_tr_b16 v[56:57], v13 offset:0
    ds_read_b64_tr_b16 v[58:59], v13 offset:512
    ds_read_b128 v[24:27], v8 offset:0
    ds_read_b128 v[28:31], v8 offset:2048
    ds_read_b128 v[32:35], v8 offset:4096
    ds_read_b128 v[36:39], v8 offset:6144
    ds_read_b64_tr_b16 v[60:61], v14 offset:0
    ds_read_b64_tr_b16 v[62:63], v14 offset:512
    ds_read_b64_tr_b16 v[64:65], v15 offset:0
    ds_read_b64_tr_b16 v[66:67], v15 offset:512
    ds_read_b64_tr_b16 v[68:69], v16 offset:0
    ds_read_b64_tr_b16 v[70:71], v16 offset:512
    ds_read_b64_tr_b16 v[72:73], v17 offset:0
    ds_read_b64_tr_b16 v[74:75], v17 offset:512
    ds_read_b64_tr_b16 v[76:77], v18 offset:0
    ds_read_b64_tr_b16 v[78:79], v18 offset:512
    s_mov_b32 m0, s53
    s_add_u32 s93, s42, s59
    buffer_load_dwordx4 v7, s[20:23], s93 offen lds
    s_add_u32 s53, s53, 8192
    s_cmp_ge_u32 s53, 163840
    s_cselect_b32 s53, s45, s53
    s_mov_b32 m0, s53
    s_add_u32 s93, s42, s60
    buffer_load_dwordx4 v7, s[20:23], s93 offen lds
    s_add_u32 s53, s53, 8192
    s_cmp_ge_u32 s53, 163840
    s_cselect_b32 s53, s45, s53
    s_waitcnt lgkmcnt(0)
    v_mfma_f32_16x16x32_bf16 v[104:107], v[56:59], v[24:27], 0
    s_mov_b32 m0, s53
    s_add_u32 s93, s42, s61
    buffer_load_dwordx4 v7, s[20:23], s93 offen lds
    s_add_u32 s53, s53, 8192
    s_cmp_ge_u32 s53, 163840
    s_cselect_b32 s53, s45, s53
    s_add_u32 s42, s42, 393216
    s_cmp_ge_u32 s42, 6291456
    s_cselect_b32 s42, 0, s42
    s_add_u32 s58, s58, 1
    s_cmp_ge_u32 s58, 16
    s_cselect_b32 s22, 0, 6291456
    ds_read_b64_tr_b16 v[80:81], v13 offset:4096
    v_mfma_f32_16x16x32_bf16 v[108:111], v[56:59], v[28:31], 0
    ds_read_b64_tr_b16 v[82:83], v13 offset:4608
    v_mfma_f32_16x16x32_bf16 v[112:115], v[56:59], v[32:35], 0
    ds_read_b128 v[40:43], v9 offset:0
    v_mfma_f32_16x16x32_bf16 v[116:119], v[56:59], v[36:39], 0
    s_mov_b32 m0, s53
    s_add_u32 s93, s41, 0
    buffer_load_dwordx4 v6, s[16:19], s93 offen lds
    s_add_u32 s53, s53, 8192
    s_cmp_ge_u32 s53, 163840
    s_cselect_b32 s53, s45, s53
    ds_read_b128 v[44:47], v9 offset:2048
    v_mfma_f32_16x16x32_bf16 v[120:123], v[60:63], v[24:27], 0
    ds_read_b128 v[48:51], v9 offset:4096
    v_mfma_f32_16x16x32_bf16 v[124:127], v[60:63], v[28:31], 0
    ds_read_b128 v[52:55], v9 offset:6144
    v_mfma_f32_16x16x32_bf16 v[128:131], v[60:63], v[32:35], 0
    s_mov_b32 m0, s53
    s_add_u32 s93, s41, 131072
    buffer_load_dwordx4 v6, s[16:19], s93 offen lds
    s_add_u32 s53, s53, 8192
    s_cmp_ge_u32 s53, 163840
    s_cselect_b32 s53, s45, s53
    ds_read_b64_tr_b16 v[84:85], v14 offset:4096
    v_mfma_f32_16x16x32_bf16 v[132:135], v[60:63], v[36:39], 0
    ds_read_b64_tr_b16 v[86:87], v14 offset:4608
    v_mfma_f32_16x16x32_bf16 v[136:139], v[64:67], v[24:27], 0
    ds_read_b64_tr_b16 v[88:89], v15 offset:4096
    v_mfma_f32_16x16x32_bf16 v[140:143], v[64:67], v[28:31], 0
    s_mov_b32 m0, s53
    s_add_u32 s93, s41, 262144
    buffer_load_dwordx4 v6, s[16:19], s93 offen lds
    s_add_u32 s53, s53, 8192
    s_cmp_ge_u32 s53, 163840
    s_cselect_b32 s53, s45, s53
    ds_read_b64_tr_b16 v[90:91], v15 offset:4608
    v_mfma_f32_16x16x32_bf16 v[144:147], v[64:67], v[32:35], 0
    ds_read_b64_tr_b16 v[92:93], v16 offset:4096
    v_mfma_f32_16x16x32_bf16 v[148:151], v[64:67], v[36:39], 0
    ds_read_b64_tr_b16 v[94:95], v16 offset:4608
    v_mfma_f32_16x16x32_bf16 v[152:155], v[68:71], v[24:27], 0
    s_mov_b32 m0, s53
    s_add_u32 s93, s41, 393216
    buffer_load_dwordx4 v6, s[16:19], s93 offen lds
    s_add_u32 s53, s53, 8192
    s_cmp_ge_u32 s53, 163840
    s_cselect_b32 s53, s45, s53
    s_add_u32 s41, s41, 128
    s_and_b32 s41, s41, 2047
    s_add_u32 s57, s57, 1
    s_cmp_ge_u32 s57, 16
    s_cselect_b32 s18, 0, 524288
    ds_read_b64_tr_b16 v[96:97], v17 offset:4096
    v_mfma_f32_16x16x32_bf16 v[156:159], v[68:71], v[28:31], 0
    ds_read_b64_tr_b16 v[98:99], v17 offset:4608
    v_mfma_f32_16x16x32_bf16 v[160:163], v[68:71], v[32:35], 0
    ds_read_b64_tr_b16 v[100:101], v18 offset:4096
    v_mfma_f32_16x16x32_bf16 v[164:167], v[68:71], v[36:39], 0
    ds_read_b64_tr_b16 v[102:103], v18 offset:4608
    v_mfma_f32_16x16x32_bf16 v[168:171], v[24:27], v[72:75], 0
    v_mfma_f32_16x16x32_bf16 v[172:175], v[28:31], v[72:75], 0
    v_mfma_f32_16x16x32_bf16 v[176:179], v[32:35], v[72:75], 0
    v_mfma_f32_16x16x32_bf16 v[180:183], v[36:39], v[72:75], 0
    s_add_u32 s67, s67, 57344
    s_sub_u32 s55, s67, 163840
    s_min_u32 s67, s67, s55
    v_add_u32 v13, s67, v11
    v_mfma_f32_16x16x32_bf16 v[184:187], v[24:27], v[76:79], 0
    v_add_u32 v14, s67, v12
    s_add_u32 s94, s67, 8192
    s_sub_u32 s55, s94, 163840
    s_min_u32 s94, s94, s55
    v_mfma_f32_16x16x32_bf16 v[188:191], v[28:31], v[76:79], 0
    v_add_u32 v15, s94, v11
    v_add_u32 v16, s94, v12
    s_add_u32 s94, s67, 16384
    s_sub_u32 s55, s94, 163840
    v_mfma_f32_16x16x32_bf16 v[192:195], v[32:35], v[76:79], 0
    s_min_u32 s94, s94, s55
    v_add_u32 v17, s94, v11
    v_add_u32 v18, s94, v12
    s_add_u32 s94, s67, s36
    v_mfma_f32_16x16x32_bf16 v[196:199], v[36:39], v[76:79], 0
    s_sub_u32 s55, s94, 163840
    s_min_u32 s94, s94, s55
    v_add_u32 v8, s94, v10
    v_xor_b32 v9, 64, v8
    s_waitcnt vmcnt(0) lgkmcnt(0)
    s_barrier
    s_or_b32 s94, s2, s3
    s_cmp_eq_u32 s94, 0
    s_cbranch_scc1 L_pubini
L_pubini_b:
    v_mfma_f32_16x16x32_bf16 v[104:107], v[80:83], v[40:43], v[104:107]
    s_mov_b32 m0, s53
    s_add_u32 s93, s42, s59
    buffer_load_dwordx4 v7, s[20:23], s93 offen lds
    s_add_u32 s53, s53, 8192
    s_cmp_ge_u32 s53, 163840
    s_cselect_b32 s53, s45, s53
    ds_read_b64_tr_b16 v[56:57], v13 offset:0
    v_mfma_f32_16x16x32_bf16 v[108:111], v[80:83], v[44:47], v[108:111]
    ds_read_b64_tr_b16 v[58:59], v13 offset:512
    v_mfma_f32_16x16x32_bf16 v[112:115], v[80:83], v[48:51], v[112:115]
    s_mov_b32 m0, s53
    s_add_u32 s93, s42, s60
    buffer_load_dwordx4 v7, s[20:23], s93 offen lds
    s_add_u32 s53, s53, 8192
    s_cmp_ge_u32 s53, 163840
    s_cselect_b32 s53, s45, s53
    ds_read_b128 v[24:27], v8 offset:0
    v_mfma_f32_16x16x32_bf16 v[116:119], v[80:83], v[52:55], v[116:119]
    ds_read_b128 v[28:31], v8 offset:2048
    v_mfma_f32_16x16x32_bf16 v[120:123], v[84:87], v[40:43], v[120:123]
    s_mov_b32 m0, s53
    s_add_u32 s93, s42, s61
    buffer_load_dwordx4 v7, s[20:23], s93 offen lds
    s_add_u32 s53, s53, 8192
    s_cmp_ge_u32 s53, 163840
    s_cselect_b32 s53, s45, s53
    s_add_u32 s42, s42, 393216
    s_cmp_ge_u32 s42, 6291456
    s_cselect_b32 s42, 0, s42
    s_add_u32 s58, s58, 1
    s_cmp_ge_u32 s58, 16
    s_cselect_b32 s22, 0, 6291456
    v_mfma_f32_16x16x32_bf16 v[124:127], v[84:87], v[44:47], v[124:127]
    ds_read_b128 v[32:35], v8 offset:4096
    v_mfma_f32_16x16x32_bf16 v[128:131], v[84:87], v[48:51], v[128:131]
    ds_read_b128 v[36:39], v8 offset:6144
    v_mfma_f32_16x16x32_bf16 v[132:135], v[84:87], v[52:55], v[132:135]
    s_mov_b32 m0, s53
    s_add_u32 s93, s41, 0
    buffer_load_dwordx4 v6, s[16:19], s93 offen lds
    s_add_u32 s53, s53, 8192
    s_cmp_ge_u32 s53, 163840
    s_cselect_b32 s53, s45, s53
    v_mfma_f32_16x16x32_bf16 v[136:139], v[88:91], v[40:43], v[136:139]
    ds_read_b64_tr_b16 v[60:61], v14 offset:0
    v_mfma_f32_16x16x32_bf16 v[140:143], v[88:91], v[44:47], v[140:143]
    s_mov_b32 m0, s53
    s_add_u32 s93, s41, 131072
    buffer_load_dwordx4 v6, s[16:19], s93 offen lds
    s_add_u32 s53, s53, 8192
    s_cmp_ge_u32 s53, 163840
    s_cselect_b32 s53, s45, s53
    v_mfma_f32_16x16x32_bf16 v[144:147], v[88:91], v[48:51], v[144:147]
    ds_read_b64_tr_b16 v[62:63], v14 offset:512
    v_mfma_f32_16x16x32_bf16 v[148:151], v[88:91], v[52:55], v[148:151]
    ds_read_b64_tr_b16 v[64:65], v15 offset:0
    v_mfma_f32_16x16x32_bf16 v[152:155], v[92:95], v[40:43], v[152:155]
    s_mov_b32 m0, s53
    s_add_u32 s93, s41, 262144
    buffer_load_dwordx4 v6, s[16:19], s93 offen lds
    s_add_u32 s53, s53, 8192
    s_cmp_ge_u32 s53, 163840
    s_cselect_b32 s53, s45, s53
    v_mfma_f32_16x16x32_bf16 v[156:159], v[92:95], v[44:47], v[156:159]
    ds_read_b64_tr_b16 v[66:67], v15 offset:512
    v_mfma_f32_16x16x32_bf16 v[160:163], v[92:95], v[48:51], v[160:163]
    s_mov_b32 m0, s53
    s_add_u32 s93, s41, 393216
    buffer_load_dwordx4 v6, s[16:19], s93 offen lds
    s_add_u32 s53, s53, 8192
    s_cmp_ge_u32 s53, 163840
    s_cselect_b32 s53, s45, s53
    s_add_u32 s41, s41, 128
    s_and_b32 s41, s41, 2047
    s_add_u32 s57, s57, 1
    s_cmp_ge_u32 s57, 16
    s_cselect_b32 s18, 0, 524288
    v_mfma_f32_16x16x32_bf16 v[164:167], v[92:95], v[52:55], v[164:167]
    ds_read_b64_tr_b16 v[68:69], v16 offset:0
    v_mfma_f32_16x16x32_bf16 v[168:171], v[40:43], v[96:99], v[168:171]
    s_mov_b32 m0, s53
    s_add_u32 s93, s42, s59
    buffer_load_dwordx4 v7, s[20:23], s93 offen lds
    s_add_u32 s53, s53, 8192
    s_cmp_ge_u32 s53, 163840
    s_cselect_b32 s53, s45, s53
    v_mfma_f32_16x16x32_bf16 v[172:175], v[44:47], v[96:99], v[172:175]
    ds_read_b64_tr_b16 v[70:71], v16 offset:512
    v_mfma_f32_16x16x32_bf16 v[176:179], v[48:51], v[96:99], v[176:179]
    ds_read_b64_tr_b16 v[72:73], v17 offset:0
    v_mfma_f32_16x16x32_bf16 v[180:183], v[52:55], v[96:99], v[180:183]
    s_mov_b32 m0, s53
    s_add_u32 s93, s42, s60
    buffer_load_dwordx4 v7, s[20:23], s93 offen lds
    s_add_u32 s53, s53, 8192
    s_cmp_ge_u32 s53, 163840
    s_cselect_b32 s53, s45, s53
    v_mfma_f32_16x16x32_bf16 v[184:187], v[40:43], v[100:103], v[184:187]
    ds_read_b64_tr_b16 v[74:75], v17 offset:512
    v_mfma_f32_16x16x32_bf16 v[188:191], v[44:47], v[100:103], v[188:191]
    s_mov_b32 m0, s53
    s_add_u32 s93, s42, s61
    buffer_load_dwordx4 v7, s[20:23], s93 offen lds
    s_add_u32 s53, s53, 8192
    s_cmp_ge_u32 s53, 163840
    s_cselect_b32 s53, s45, s53
    s_add_u32 s42, s42, 393216
    s_cmp_ge_u32 s42, 6291456
    s_cselect_b32 s42, 0, s42
    s_add_u32 s58, s58, 1
    s_cmp_ge_u32 s58, 16
    s_cselect_b32 s22, 0, 6291456
    v_mfma_f32_16x16x32_bf16 v[192:195], v[48:51], v[100:103], v[192:195]
    ds_read_b64_tr_b16 v[76:77], v18 offset:0
    v_mfma_f32_16x16x32_bf16 v[196:199], v[52:55], v[100:103], v[196:199]
    ds_read_b64_tr_b16 v[78:79], v18 offset:512
    s_mov_b32 s40, 0
.p2align 6
L_gloop:
    s_waitcnt lgkmcnt(0)
    v_mfma_f32_16x16x32_bf16 v[104:107], v[56:59], v[24:27], v[104:107]
    ds_read_b64_tr_b16 v[80:81], v13 offset:4096
    v_mfma_f32_16x16x32_bf16 v[108:111], v[56:59], v[28:31], v[108:111]
    ds_read_b64_tr_b16 v[82:83], v13 offset:4608
    v_mfma_f32_16x16x32_bf16 v[112:115], v[56:59], v[32:35], v[112:115]
    s_mov_b32 m0, s53
    s_add_u32 s93, s41, 0
    buffer_load_dwordx4 v6, s[16:19], s93 offen lds
    s_add_u32 s53, s53, 8192
    s_cmp_ge_u32 s53, 163840
    s_cselect_b32 s53, s45, s53
    v_mfma_f32_16x16x32_bf16 v[116:119], v[56:59], v[36:39], v[116:119]
    ds_read_b128 v[40:43], v9 offset:0
    v_mfma_f32_16x16x32_bf16 v[120:123], v[60:63], v[24:27], v[120:123]
    ds_read_b128 v[44:47], v9 offset:2048
    v_mfma_f32_16x16x32_bf16 v[124:127], v[60:63], v[28:31], v[124:127]
    ds_read_b128 v[48:51], v9 offset:4096
    v_mfma_f32_16x16x32_bf16 v[128:131], v[60:63], v[32:35], v[128:131]
    ds_read_b128 v[52:55], v9 offset:6144
    v_mfma_f32_16x16x32_bf16 v[132:135], v[60:63], v[36:39], v[132:135]
    ds_read_b64_tr_b16 v[84:85], v14 offset:4096
    s_setprio 1
    v_mfma_f32_16x16x32_bf16 v[136:139], v[64:67], v[24:27], v[136:139]
    s_mov_b32 m0, s53
    s_add_u32 s93, s41, 131072
    buffer_load_dwordx4 v6, s[16:19], s93 offen lds
    s_add_u32 s53, s53, 8192
    s_cmp_ge_u32 s53, 163840
    s_cselect_b32 s53, s45, s53
    v_mfma_f32_16x16x32_bf16 v[140:143], v[64:67], v[28:31], v[140:143]
    ds_read_b64_tr_b16 v[86:87], v14 offset:4608
    v_mfma_f32_16x16x32_bf16 v[144:147], v[64:67], v[32:35], v[144:147]
    ds_read_b64_tr_b16 v[88:89], v15 offset:4096
    v_mfma_f32_16x16x32_bf16 v[148:151], v[64:67], v[36:39], v[148:151]
    ds_read_b64_tr_b16 v[90:91], v15 offset:4608
    v_mfma_f32_16x16x32_bf16 v[152:155], v[68:71], v[24:27], v[152:155]
    ds_read_b64_tr_b16 v[92:93], v16 offset:4096
    v_mfma_f32_16x16x32_bf16 v[156:159], v[68:71], v[28:31], v[156:159]
    ds_read_b64_tr_b16 v[94:95], v16 offset:4608
    v_mfma_f32_16x16x32_bf16 v[160:163], v[68:71], v[32:35], v[160:163]
    s_mov_b32 m0, s53
    s_add_u32 s93, s41, 262144
    buffer_load_dwordx4 v6, s[16:19], s93 offen lds
    s_add_u32 s53, s53, 8192
    s_cmp_ge_u32 s53, 163840
    s_cselect_b32 s53, s45, s53
    v_mfma_f32_16x16x32_bf16 v[164:167], v[68:71], v[36:39], v[164:167]
    ds_read_b64_tr_b16 v[96:97], v17 offset:4096
    v_mfma_f32_16x16x32_bf16 v[168:171], v[24:27], v[72:75], v[168:171]
    ds_read_b64_tr_b16 v[98:99], v17 offset:4608
    v_mfma_f32_16x16x32_bf16 v[172:175], v[28:31], v[72:75], v[172:175]
    ds_read_b64_tr_b16 v[100:101], v18 offset:4096
    s_setprio 0
    v_mfma_f32_16x16x32_bf16 v[176:179], v[32:35], v[72:75], v[176:179]
    ds_read_b64_tr_b16 v[102:103], v18 offset:4608
    v_mfma_f32_16x16x32_bf16 v[180:183], v[36:39], v[72:75], v[180:183]
    s_add_u32 s67, s67, 57344
    s_sub_u32 s55, s67, 163840
    s_min_u32 s67, s67, s55
    v_add_u32 v13, s67, v11
    v_mfma_f32_16x16x32_bf16 v[184:187], v[24:27], v[76:79], v[184:187]
    v_add_u32 v14, s67, v12
    s_add_u32 s94, s67, 8192
    s_sub_u32 s55, s94, 163840
    s_min_u32 s94, s94, s55
    v_mfma_f32_16x16x32_bf16 v[188:191], v[28:31], v[76:79], v[188:191]
    v_add_u32 v15, s94, v11
    v_add_u32 v16, s94, v12
    s_add_u32 s94, s67, 16384
    s_sub_u32 s55, s94, 163840
    v_mfma_f32_16x16x32_bf16 v[192:195], v[32:35], v[76:79], v[192:195]
    s_min_u32 s94, s94, s55
    v_add_u32 v17, s94, v11
    v_add_u32 v18, s94, v12
    s_add_u32 s94, s67, s36
    v_mfma_f32_16x16x32_bf16 v[196:199], v[36:39], v[76:79], v[196:199]
    s_sub_u32 s55, s94, 163840
    s_min_u32 s94, s94, s55
    v_add_u32 v8, s94, v10
    v_xor_b32 v9, 64, v8
    s_waitcnt vmcnt(6) lgkmcnt(0)
    s_barrier
    s_setprio 3
    v_mfma_f32_16x16x32_bf16 v[104:107], v[80:83], v[40:43], v[104:107]
    s_mov_b32 m0, s53
    s_add_u32 s93, s41, 393216
    buffer_load_dwordx4 v6, s[16:19], s93 offen lds
    s_add_u32 s53, s53, 8192
    s_cmp_ge_u32 s53, 163840
    s_cselect_b32 s53, s45, s53
    s_add_u32 s41, s41, 128
    s_and_b32 s41, s41, 2047
    s_add_u32 s57, s57, 1
    s_cmp_ge_u32 s57, 16
    s_cselect_b32 s18, 0, 524288
    v_mfma_f32_16x16x32_bf16 v[108:111], v[80:83], v[44:47], v[108:111]
    ds_read_b64_tr_b16 v[56:57], v13 offset:0
    v_mfma_f32_16x16x32_bf16 v[112:115], v[80:83], v[48:51], v[112:115]
    ds_read_b64_tr_b16 v[58:59], v13 offset:512
    v_mfma_f32_16x16x32_bf16 v[116:119], v[80:83], v[52:55], v[116:119]
    ds_read_b128 v[24:27], v8 offset:0
    v_mfma_f32_16x16x32_bf16 v[120:123], v[84:87], v[40:43], v[120:123]
    ds_read_b128 v[28:31], v8 offset:2048
    v_mfma_f32_16x16x32_bf16 v[124:127], v[84:87], v[44:47], v[124:127]
    ds_read_b128 v[32:35], v8 offset:4096
    v_mfma_f32_16x16x32_bf16 v[128:131], v[84:87], v[48:51], v[128:131]
    s_mov_b32 m0, s53
    s_add_u32 s93, s42, s59
    buffer_load_dwordx4 v7, s[20:23], s93 offen lds
    s_add_u32 s53, s53, 8192
    s_cmp_ge_u32 s53, 163840
    s_cselect_b32 s53, s45, s53
    v_mfma_f32_16x16x32_bf16 v[132:135], v[84:87], v[52:55], v[132:135]
    ds_read_b128 v[36:39], v8 offset:6144
    v_mfma_f32_16x16x32_bf16 v[136:139], v[88:91], v[40:43], v[136:139]
    ds_read_b64_tr_b16 v[60:61], v14 offset:0
    v_mfma_f32_16x16x32_bf16 v[140:143], v[88:91], v[44:47], v[140:143]
    ds_read_b64_tr_b16 v[62:63], v14 offset:512
    v_mfma_f32_16x16x32_bf16 v[144:147], v[88:91], v[48:51], v[144:147]
    ds_read_b64_tr_b16 v[64:65], v15 offset:0
    v_mfma_f32_16x16x32_bf16 v[148:151], v[88:91], v[52:55], v[148:151]
    ds_read_b64_tr_b16 v[66:67], v15 offset:512
    v_mfma_f32_16x16x32_bf16 v[152:155], v[92:95], v[40:43], v[152:155]
    s_mov_b32 m0, s53
    s_add_u32 s93, s42, s60
    buffer_load_dwordx4 v7, s[20:23], s93 offen lds
    s_add_u32 s53, s53, 8192
    s_cmp_ge_u32 s53, 163840
    s_cselect_b32 s53, s45, s53
    v_mfma_f32_16x16x32_bf16 v[156:159], v[92:95], v[44:47], v[156:159]
    ds_read_b64_tr_b16 v[68:69], v16 offset:0
    v_mfma_f32_16x16x32_bf16 v[160:163], v[92:95], v[48:51], v[160:163]
    ds_read_b64_tr_b16 v[70:71], v16 offset:512
    v_mfma_f32_16x16x32_bf16 v[164:167], v[92:95], v[52:55], v[164:167]
    ds_read_b64_tr_b16 v[72:73], v17 offset:0
    s_setprio 2
    v_mfma_f32_16x16x32_bf16 v[168:171], v[40:43], v[96:99], v[168:171]
    ds_read_b64_tr_b16 v[74:75], v17 offset:512
    v_mfma_f32_16x16x32_bf16 v[172:175], v[44:47], v[96:99], v[172:175]
    ds_read_b64_tr_b16 v[76:77], v18 offset:0
    v_mfma_f32_16x16x32_bf16 v[176:179], v[48:51], v[96:99], v[176:179]
    s_mov_b32 m0, s53
    s_add_u32 s93, s42, s61
    buffer_load_dwordx4 v7, s[20:23], s93 offen lds
    s_add_u32 s53, s53, 8192
    s_cmp_ge_u32 s53, 163840
    s_cselect_b32 s53, s45, s53
    s_add_u32 s42, s42, 393216
    s_cmp_ge_u32 s42, 6291456
    s_cselect_b32 s42, 0, s42
    s_add_u32 s58, s58, 1
    s_cmp_ge_u32 s58, 16
    s_cselect_b32 s22, 0, 6291456
    v_mfma_f32_16x16x32_bf16 v[180:183], v[52:55], v[96:99], v[180:183]
    ds_read_b64_tr_b16 v[78:79], v18 offset:512
    v_mfma_f32_16x16x32_bf16 v[184:187], v[40:43], v[100:103], v[184:187]
    v_mfma_f32_16x16x32_bf16 v[188:191], v[44:47], v[100:103], v[188:191]
    v_mfma_f32_16x16x32_bf16 v[192:195], v[48:51], v[100:103], v[192:195]
    v_mfma_f32_16x16x32_bf16 v[196:199], v[52:55], v[100:103], v[196:199]
    s_add_u32 s40, s40, 1
    s_cmp_lt_u32 s40, 14
    s_cbranch_scc1 L_gloop
    s_waitcnt lgkmcnt(0)
    v_mfma_f32_16x16x32_bf16 v[104:107], v[56:59], v[24:27], v[104:107]
    ds_read_b64_tr_b16 v[80:81], v13 offset:4096
    v_mfma_f32_16x16x32_bf16 v[108:111], v[56:59], v[28:31], v[108:111]
    ds_read_b64_tr_b16 v[82:83], v13 offset:4608
    v_mfma_f32_16x16x32_bf16 v[112:115], v[56:59], v[32:35], v[112:115]
    ds_read_b128 v[40:43], v9 offset:0
    v_mfma_f32_16x16x32_bf16 v[116:119], v[56:59], v[36:39], v[116:119]
    ds_read_b128 v[44:47], v9 offset:2048
    v_mfma_f32_16x16x32_bf16 v[120:123], v[60:63], v[24:27], v[120:123]
    ds_read_b128 v[48:51], v9 offset:4096
    v_mfma_f32_16x16x32_bf16 v[124:127], v[60:63], v[28:31], v[124:127]
    ds_read_b128 v[52:55], v9 offset:6144
    v_mfma_f32_16x16x32_bf16 v[128:131], v[60:63], v[32:35], v[128:131]
    ds_read_b64_tr_b16 v[84:85], v14 offset:4096
    v_mfma_f32_16x16x32_bf16 v[132:135], v[60:63], v[36:39], v[132:135]
    ds_read_b64_tr_b16 v[86:87], v14 offset:4608
    v_mfma_f32_16x16x32_bf16 v[136:139], v[64:67], v[24:27], v[136:139]
    ds_read_b64_tr_b16 v[88:89], v15 offset:4096
    v_mfma_f32_16x16x32_bf16 v[140:143], v[64:67], v[28:31], v[140:143]
    ds_read_b64_tr_b16 v[90:91], v15 offset:4608
    v_mfma_f32_16x16x32_bf16 v[144:147], v[64:67], v[32:35], v[144:147]
    ds_read_b64_tr_b16 v[92:93], v16 offset:4096
    v_mfma_f32_16x16x32_bf16 v[148:151], v[64:67], v[36:39], v[148:151]
    ds_read_b64_tr_b16 v[94:95], v16 offset:4608
    v_mfma_f32_16x16x32_bf16 v[152:155], v[68:71], v[24:27], v[152:155]
    ds_read_b64_tr_b16 v[96:97], v17 offset:4096
    v_mfma_f32_16x16x32_bf16 v[156:159], v[68:71], v[28:31], v[156:159]
    ds_read_b64_tr_b16 v[98:99], v17 offset:4608
    v_mfma_f32_16x16x32_bf16 v[160:163], v[68:71], v[32:35], v[160:163]
    ds_read_b64_tr_b16 v[100:101], v18 offset:4096
    v_mfma_f32_16x16x32_bf16 v[164:167], v[68:71], v[36:39], v[164:167]
    ds_read_b64_tr_b16 v[102:103], v18 offset:4608
    v_mfma_f32_16x16x32_bf16 v[168:171], v[24:27], v[72:75], v[168:171]
    v_mfma_f32_16x16x32_bf16 v[172:175], v[28:31], v[72:75], v[172:175]
    v_mfma_f32_16x16x32_bf16 v[176:179], v[32:35], v[72:75], v[176:179]
    v_mfma_f32_16x16x32_bf16 v[180:183], v[36:39], v[72:75], v[180:183]
    v_mfma_f32_16x16x32_bf16 v[184:187], v[24:27], v[76:79], v[184:187]
    v_mfma_f32_16x16x32_bf16 v[188:191], v[28:31], v[76:79], v[188:191]
    v_mfma_f32_16x16x32_bf16 v[192:195], v[32:35], v[76:79], v[192:195]
    v_mfma_f32_16x16x32_bf16 v[196:199], v[36:39], v[76:79], v[196:199]
    s_waitcnt lgkmcnt(0)
    s_mov_b32 s28, s10
    s_mov_b32 s29, s11
    s_mov_b32 s30, 2048
    s_mov_b32 s31, 0x00020000
    s_mov_b32 s18, 524288
    s_lshl_b32 s93, s33, 3
    s_add_u32 s93, s93, s3
    s_lshl_b32 s94, s93, 11
    v_lshlrev_b32 v2, 5, v1
    v_mov_b32 v3, 0
    v_mfma_f32_16x16x32_bf16 v[136:139], v[88:91], v[40:43], v[136:139]
    v_mfma_f32_16x16x32_bf16 v[140:143], v[88:91], v[44:47], v[140:143]
    buffer_load_dwordx4 v[24:27], v2, s[16:19], s94 offen
    v_mfma_f32_16x16x32_bf16 v[144:147], v[88:91], v[48:51], v[144:147]
    v_mfma_f32_16x16x32_bf16 v[148:151], v[88:91], v[52:55], v[148:151]
    v_mfma_f32_16x16x32_bf16 v[152:155], v[92:95], v[40:43], v[152:155]
    v_mfma_f32_16x16x32_bf16 v[156:159], v[92:95], v[44:47], v[156:159]
    buffer_load_dwordx4 v[28:31], v2, s[16:19], s94 offen offset:16
    v_mfma_f32_16x16x32_bf16 v[160:163], v[92:95], v[48:51], v[160:163]
    v_mfma_f32_16x16x32_bf16 v[164:167], v[92:95], v[52:55], v[164:167]
    v_mfma_f32_16x16x32_bf16 v[168:171], v[40:43], v[96:99], v[168:171]
    v_mfma_f32_16x16x32_bf16 v[172:175], v[44:47], v[96:99], v[172:175]
    buffer_load_dwordx4 v[32:35], v2, s[28:31], 0 offen
    v_mfma_f32_16x16x32_bf16 v[176:179], v[48:51], v[96:99], v[176:179]
    v_mfma_f32_16x16x32_bf16 v[180:183], v[52:55], v[96:99], v[180:183]
    v_mfma_f32_16x16x32_bf16 v[184:187], v[40:43], v[100:103], v[184:187]
    v_mfma_f32_16x16x32_bf16 v[188:191], v[44:47], v[100:103], v[188:191]
    buffer_load_dwordx4 v[36:39], v2, s[28:31], 0 offen offset:16
    v_mfma_f32_16x16x32_bf16 v[192:195], v[48:51], v[100:103], v[192:195]
    v_mfma_f32_16x16x32_bf16 v[196:199], v[52:55], v[100:103], v[196:199]
    v_mfma_f32_16x16x32_bf16 v[104:107], v[80:83], v[40:43], v[104:107]
    v_mfma_f32_16x16x32_bf16 v[108:111], v[80:83], v[44:47], v[108:111]
    buffer_load_dword v21, v3, s[72:75], 0 offen sc1
    v_mfma_f32_16x16x32_bf16 v[112:115], v[80:83], v[48:51], v[112:115]
    v_mfma_f32_16x16x32_bf16 v[116:119], v[80:83], v[52:55], v[116:119]
    v_mfma_f32_16x16x32_bf16 v[120:123], v[84:87], v[40:43], v[120:123]
    v_mfma_f32_16x16x32_bf16 v[124:127], v[84:87], v[44:47], v[124:127]
    v_mfma_f32_16x16x32_bf16 v[128:131], v[84:87], v[48:51], v[128:131]
    v_mfma_f32_16x16x32_bf16 v[132:135], v[84:87], v[52:55], v[132:135]
    s_mov_b32 s48, 0x3e8293ee
    s_mov_b32 s49, 0x3e8293ee
    v_cvt_pk_bf16_f32 v200, v136, v137
    v_cvt_pk_bf16_f32 v201, v138, v139
    v_cvt_pk_bf16_f32 v202, v152, v153
    v_cvt_pk_bf16_f32 v203, v154, v155
    buffer_store_dwordx4 v[200:203], v249, s[76:79], s85 offen offset:0 sc1
    v_cvt_pk_bf16_f32 v204, v140, v141
    v_cvt_pk_bf16_f32 v205, v142, v143
    v_cvt_pk_bf16_f32 v206, v156, v157
    v_cvt_pk_bf16_f32 v207, v158, v159
    buffer_store_dwordx4 v[204:207], v249, s[76:79], s85 offen offset:128 sc1
    v_cvt_pk_bf16_f32 v208, v144, v145
    v_cvt_pk_bf16_f32 v209, v146, v147
    v_cvt_pk_bf16_f32 v210, v160, v161
    v_cvt_pk_bf16_f32 v211, v162, v163
    buffer_store_dwordx4 v[208:211], v249, s[76:79], s86 offen offset:0 sc1
    v_cvt_pk_bf16_f32 v212, v148, v149
    v_cvt_pk_bf16_f32 v213, v150, v151
    v_cvt_pk_bf16_f32 v214, v164, v165
    v_cvt_pk_bf16_f32 v215, v166, v167
    buffer_store_dwordx4 v[212:215], v249, s[76:79], s86 offen offset:128 sc1
    v_cvt_pk_bf16_f32 v216, v168, v169
    v_cvt_pk_bf16_f32 v217, v170, v171
    v_cvt_pk_bf16_f32 v218, v172, v173
    v_cvt_pk_bf16_f32 v219, v174, v175
    buffer_store_dwordx4 v[216:219], v248, s[76:79], s87 offen offset:2048 sc1
    v_cvt_pk_bf16_f32 v220, v184, v185
    v_cvt_pk_bf16_f32 v221, v186, v187
    v_cvt_pk_bf16_f32 v222, v188, v189
    v_cvt_pk_bf16_f32 v223, v190, v191
    buffer_store_dwordx4 v[220:223], v248, s[76:79], s87 offen offset:2304 sc1
    v_cvt_pk_bf16_f32 v224, v176, v177
    v_cvt_pk_bf16_f32 v225, v178, v179
    v_cvt_pk_bf16_f32 v226, v180, v181
    v_cvt_pk_bf16_f32 v227, v182, v183
    buffer_store_dwordx4 v[224:227], v248, s[76:79], s88 offen offset:2048 sc1
    v_cvt_pk_bf16_f32 v228, v192, v193
    v_cvt_pk_bf16_f32 v229, v194, v195
    v_cvt_pk_bf16_f32 v230, v196, v197
    v_cvt_pk_bf16_f32 v231, v198, v199
    buffer_store_dwordx4 v[228:231], v248, s[76:79], s88 offen offset:2304 sc1
    v_pk_mul_f32 v[104:105], v[104:105], s[48:49]
    v_pk_mul_f32 v[106:107], v[106:107], s[48:49]
    v_pk_mul_f32 v[120:121], v[120:121], s[48:49]
    v_pk_mul_f32 v[122:123], v[122:123], s[48:49]
    v_cvt_pk_bf16_f32 v232, v104, v105
    v_cvt_pk_bf16_f32 v233, v106, v107
    v_cvt_pk_bf16_f32 v234, v120, v121
    v_cvt_pk_bf16_f32 v235, v122, v123
    buffer_store_dwordx4 v[232:235], v248, s[76:79], s84 offen offset:0 sc1
    v_pk_mul_f32 v[108:109], v[108:109], s[48:49]
    v_pk_mul_f32 v[110:111], v[110:111], s[48:49]
    v_pk_mul_f32 v[124:125], v[124:125], s[48:49]
    v_pk_mul_f32 v[126:127], v[126:127], s[48:49]
    v_cvt_pk_bf16_f32 v236, v108, v109
    v_cvt_pk_bf16_f32 v237, v110, v111
    v_cvt_pk_bf16_f32 v238, v124, v125
    v_cvt_pk_bf16_f32 v239, v126, v127
    buffer_store_dwordx4 v[236:239], v248, s[76:79], s84 offen offset:256 sc1
    v_pk_mul_f32 v[112:113], v[112:113], s[48:49]
    v_pk_mul_f32 v[114:115], v[114:115], s[48:49]
    v_pk_mul_f32 v[128:129], v[128:129], s[48:49]
    v_pk_mul_f32 v[130:131], v[130:131], s[48:49]
    v_cvt_pk_bf16_f32 v240, v112, v113
    v_cvt_pk_bf16_f32 v241, v114, v115
    v_cvt_pk_bf16_f32 v242, v128, v129
    v_cvt_pk_bf16_f32 v243, v130, v131
    buffer_store_dwordx4 v[240:243], v248, s[76:79], s84 offen offset:2048 sc1
    v_pk_mul_f32 v[116:117], v[116:117], s[48:49]
    v_pk_mul_f32 v[118:119], v[118:119], s[48:49]
    v_pk_mul_f32 v[132:133], v[132:133], s[48:49]
    v_pk_mul_f32 v[134:135], v[134:135], s[48:49]
    v_cvt_pk_bf16_f32 v244, v116, v117
    v_cvt_pk_bf16_f32 v245, v118, v119
    v_cvt_pk_bf16_f32 v246, v132, v133
    v_cvt_pk_bf16_f32 v247, v134, v135
    buffer_store_dwordx4 v[244:247], v248, s[76:79], s84 offen offset:2304 sc1
    s_and_b32 s93, s2, 7
    s_lshl_b32 s93, s93, 1
    s_bfe_u32 s94, s2, 0x10004
    s_add_u32 s93, s93, s94
    v_lshrrev_b32 v4, 3, v1
    v_mov_b32 v5, 0
    v_cmp_eq_u32 vcc, 1, v4
    v_mov_b32 v2, 0
    s_nop 0
    v_cndmask_b32 v5, v5, v2, vcc
    v_cmp_eq_u32 vcc, 0, v4
    v_mov_b32 v2, 1
    s_nop 0
    v_cndmask_b32 v5, v5, v2, vcc
    v_sub_u32 v5, s93, v5
    v_and_b32 v5, 15, v5
    v_add_u32 v5, 16, v5
    v_and_b32 v2, 7, v1
    s_lshr_b32 s93, s2, 5
    v_mov_b32 v253, s93
    v_cmp_eq_u32 vcc, 0, v4
    s_nop 1
    v_cndmask_b32 v4, v2, v253, vcc
    v_lshl_add_u32 v253, v5, 5, v4
    v_lshlrev_b32 v253, 2, v253
    v_add_u32 v253, 33701888, v253
    v_mov_b32 v2, 1
    s_setprio 0
    s_waitcnt vmcnt(0)
    s_barrier
    s_cmp_eq_u32 s3, 0
    s_cbranch_scc0 L_h0go
    v_readfirstlane_b32 s93, v21
    s_cmp_lg_u32 s93, 0
    s_cbranch_scc0 L_spini
L_inigo:
    s_mov_b64 exec, 1
    buffer_store_dword v2, v3, s[76:79], s92 offen sc1
    s_mov_b64 exec, -1
L_h0go:
    v_mov_b32 v116, 0
    v_lshlrev_b32 v104, 16, v24
    v_and_b32 v105, 0xffff0000, v24
    v_lshlrev_b32 v108, 16, v32
    v_and_b32 v109, 0xffff0000, v32
    v_mul_f32 v104, v104, v108
    v_mul_f32 v105, v105, v109
    v_cvt_pk_bf16_f32 v112, v104, v105
    v_lshlrev_b32 v104, 16, v112
    v_and_b32 v105, 0xffff0000, v112
    v_add_f32 v116, v116, v104
    v_add_f32 v116, v116, v105
    v_lshlrev_b32 v104, 16, v25
    v_and_b32 v105, 0xffff0000, v25
    v_lshlrev_b32 v108, 16, v33
    v_and_b32 v109, 0xffff0000, v33
    v_mul_f32 v104, v104, v108
    v_mul_f32 v105, v105, v109
    v_cvt_pk_bf16_f32 v112, v104, v105
    v_lshlrev_b32 v104, 16, v112
    v_and_b32 v105, 0xffff0000, v112
    v_add_f32 v116, v116, v104
    v_add_f32 v116, v116, v105
    v_lshlrev_b32 v104, 16, v26
    v_and_b32 v105, 0xffff0000, v26
    v_lshlrev_b32 v108, 16, v34
    v_and_b32 v109, 0xffff0000, v34
    v_mul_f32 v104, v104, v108
    v_mul_f32 v105, v105, v109
    v_cvt_pk_bf16_f32 v112, v104, v105
    v_lshlrev_b32 v104, 16, v112
    v_and_b32 v105, 0xffff0000, v112
    v_add_f32 v116, v116, v104
    v_add_f32 v116, v116, v105
    v_lshlrev_b32 v104, 16, v27
    v_and_b32 v105, 0xffff0000, v27
    v_lshlrev_b32 v108, 16, v35
    v_and_b32 v109, 0xffff0000, v35
    v_mul_f32 v104, v104, v108
    v_mul_f32 v105, v105, v109
    v_cvt_pk_bf16_f32 v112, v104, v105
    v_lshlrev_b32 v104, 16, v112
    v_and_b32 v105, 0xffff0000, v112
    v_add_f32 v116, v116, v104
    v_add_f32 v116, v116, v105
    v_lshlrev_b32 v104, 16, v28
    v_and_b32 v105, 0xffff0000, v28
    v_lshlrev_b32 v108, 16, v36
    v_and_b32 v109, 0xffff0000, v36
    v_mul_f32 v104, v104, v108
    v_mul_f32 v105, v105, v109
    v_cvt_pk_bf16_f32 v112, v104, v105
    v_lshlrev_b32 v104, 16, v112
    v_and_b32 v105, 0xffff0000, v112
    v_add_f32 v116, v116, v104
    v_add_f32 v116, v116, v105
    v_lshlrev_b32 v104, 16, v29
    v_and_b32 v105, 0xffff0000, v29
    v_lshlrev_b32 v108, 16, v37
    v_and_b32 v109, 0xffff0000, v37
    v_mul_f32 v104, v104, v108
    v_mul_f32 v105, v105, v109
    v_cvt_pk_bf16_f32 v112, v104, v105
    v_lshlrev_b32 v104, 16, v112
    v_and_b32 v105, 0xffff0000, v112
    v_add_f32 v116, v116, v104
    v_add_f32 v116, v116, v105
    v_lshlrev_b32 v104, 16, v30
    v_and_b32 v105, 0xffff0000, v30
    v_lshlrev_b32 v108, 16, v38
    v_and_b32 v109, 0xffff0000, v38
    v_mul_f32 v104, v104, v108
    v_mul_f32 v105, v105, v109
    v_cvt_pk_bf16_f32 v112, v104, v105
    v_lshlrev_b32 v104, 16, v112
    v_and_b32 v105, 0xffff0000, v112
    v_add_f32 v116, v116, v104
    v_add_f32 v116, v116, v105
    v_lshlrev_b32 v104, 16, v31
    v_and_b32 v105, 0xffff0000, v31
    v_lshlrev_b32 v108, 16, v39
    v_and_b32 v109, 0xffff0000, v39
    v_mul_f32 v104, v104, v108
    v_mul_f32 v105, v105, v109
    v_cvt_pk_bf16_f32 v112, v104, v105
    v_lshlrev_b32 v104, 16, v112
    v_and_b32 v105, 0xffff0000, v112
    v_add_f32 v116, v116, v104
    v_add_f32 v116, v116, v105
    s_nop 1
    v_add_f32_dpp v116, v116, v116 row_shr:1 row_mask:0xf bank_mask:0xf
    s_nop 1
    v_add_f32_dpp v116, v116, v116 row_shr:2 row_mask:0xf bank_mask:0xf
    s_nop 1
    v_add_f32_dpp v116, v116, v116 row_shr:4 row_mask:0xf bank_mask:0xf
    s_nop 1
    v_add_f32_dpp v116, v116, v116 row_shr:8 row_mask:0xf bank_mask:0xf
    s_nop 1
    v_add_f32_dpp v116, v116, v116 row_bcast:15 row_mask:0xa bank_mask:0xf
    s_nop 1
    v_add_f32_dpp v116, v116, v116 row_bcast:31 row_mask:0xc bank_mask:0xf
    v_cvt_pk_bf16_f32 v112, v116, v116
    v_lshlrev_b32 v104, 16, v112
    v_mul_f32 v104, 0xbfb8aa3b, v104
    v_exp_f32 v104, v104
    s_nop 0
    v_add_f32 v104, 1.0, v104
    v_rcp_f32 v104, v104
    s_nop 0
    v_cvt_pk_bf16_f32 v112, v104, v104
    v_lshlrev_b32 v251, 16, v112
    v_sub_f32 v108, 1.0, v251
    v_cvt_pk_bf16_f32 v112, v108, v108
    v_lshlrev_b32 v252, 16, v112
    s_load_dwordx2 s[8:9], s[0:1], 56
    s_load_dwordx2 s[10:11], s[0:1], 16
    s_load_dwordx2 s[14:15], s[0:1], 40
    s_and_b32 s93, s2, 7
    s_lshr_b32 s94, s2, 3
    s_lshl_b32 s32, s93, 2
    s_and_b32 s93, s94, 3
    s_add_u32 s32, s32, s93
    s_lshr_b32 s33, s94, 2
    s_lshl_b32 s41, s33, 3
    s_add_u32 s41, s41, s3
    v_lshlrev_b32 v6, 4, v1
    s_lshl_b32 s40, s3, 12
    s_lshl_b32 s42, s32, 18
    s_add_u32 s42, s42, 8388608
    s_add_u32 s43, s42, 8388608
    s_add_u32 s39, s43, s40
    v_and_b32 v2, 31, v1
    v_lshlrev_b32 v12, 2, v2
    s_lshl_b32 s44, s32, 6
    s_add_u32 s44, s44, s41
    s_lshl_b32 s44, s44, 11
    s_mov_b32 s16, s12
    s_mov_b32 s17, s13
    s_mov_b32 s18, 38797312
    s_mov_b32 s19, 0x00020000
    s_mov_b32 s20, s12
    s_mov_b32 s21, s13
    s_mov_b32 s22, 38797312
    s_mov_b32 s23, 0x00020000
    v_lshrrev_b32 v3, 5, v1
    v_lshlrev_b32 v4, 2, v3
    v_sub_u32 v10, v2, v4
    v_mov_b32 v11, 0xf149f2ca
    v_lshrrev_b32 v4, 4, v2
    v_lshlrev_b32 v9, 10, v4
    v_lshl_add_u32 v9, v3, 8, v9
    v_and_b32 v4, 15, v1
    v_lshl_add_u32 v9, v4, 4, v9
    v_lshrrev_b32 v5, 2, v1
    v_and_b32 v4, 1, v5
    v_sub_u32 v4, v4, 1
    v_and_b32 v92, 0x3f803f80, v4
    v_mov_b32 v93, v92
    v_xor_b32 v94, 0x3f803f80, v92
    v_mov_b32 v95, v94
    v_and_b32 v4, 1, v1
    v_sub_u32 v4, 0, v4
    v_and_b32 v4, 0xaaaaaaaa, v4
    v_xor_b32 v16, 0x44444444, v4
    v_mov_b32 v96, 0
    v_mov_b32 v97, 0
    v_mov_b32 v98, 0
    v_mov_b32 v99, 0
    v_add_u32 v7, 65536, v6
    v_add_u32 v8, s40, v7
    s_movk_i32 s50, 256
    v_mov_b32 v17, 0
    v_mov_b32 v18, 1
    s_cmp_eq_u32 s3, 0
    s_cbranch_scc0 L_h1go
    buffer_load_dword v32, v253, s[16:19], 0 offen sc1
    s_waitcnt vmcnt(0)
    v_cmp_ne_u32 vcc, 0, v32
    s_nop 3
    s_cmp_eq_u64 vcc, exec
    s_cbranch_scc0 L_spf1
L_h1go:
    s_barrier
    s_add_u32 s94, s44, 4194304
    buffer_load_dwordx4 v[36:39], v6, s[16:19], s94 offen sc1
    buffer_load_dwordx4 v[40:43], v6, s[16:19], s94 offen offset:1024 sc1
    s_add_u32 m0, s40, 0
    s_add_u32 s93, s39, 0
    buffer_load_dwordx4 v6, s[16:19], s93 offen offset:0 sc1 lds
    buffer_load_dwordx4 v6, s[16:19], s93 offen offset:1024 sc1 lds
    buffer_load_dwordx4 v6, s[16:19], s93 offen offset:2048 sc1 lds
    buffer_load_dwordx4 v6, s[16:19], s93 offen offset:3072 sc1 lds
    s_max_u32 s93, s33, 1
    s_sub_u32 s93, s93, 1
    s_lshl_b32 s93, s93, 15
    s_add_u32 s51, s93, s42
    s_add_u32 s51, s51, s40
    s_lshl_b32 s93, s33, 15
    s_add_u32 s52, s93, s42
    s_add_u32 s52, s52, s40
    v_lshrrev_b32 v29, 1, v1
    v_lshlrev_b32 v29, 7, v29
    v_and_b32 v4, 1, v1
    v_lshl_add_u32 v29, v4, 4, v29
    v_add_u32 v29, 33701952, v29
    s_and_b32 s93, s2, 7
    s_lshr_b32 s94, s2, 3
    s_and_b32 s53, s93, 3
    s_lshl_b32 s53, s53, 2
    s_and_b32 s54, s94, 3
    s_add_u32 s53, s53, s54
    s_lshr_b32 s54, s93, 2
    s_lshl_b32 s54, s54, 3
    s_lshr_b32 s94, s94, 2
    s_add_u32 s54, s54, s94
    s_and_b32 s55, s3, 3
    s_lshr_b32 s56, s3, 2
    s_lshl_b32 s93, s53, 2
    s_add_u32 s93, s93, s55
    s_lshl_b32 s57, s93, 11
    s_lshl_b32 s94, s56, 17
    s_add_u32 s57, s57, s94
    s_add_u32 s57, s57, 25165824
    s_lshl_b32 s93, s93, 5
    s_lshl_b32 s94, s56, 4
    s_add_u32 s93, s93, s94
    v_and_b32 v4, 15, v1
    v_add_u32 v23, s93, v4
    v_lshlrev_b32 v23, 11, v23
    v_lshrrev_b32 v4, 4, v1
    v_and_b32 v5, 1, v4
    v_lshl_add_u32 v23, v5, 5, v23
    v_lshrrev_b32 v4, 1, v4
    v_lshl_add_u32 v23, v4, 4, v23
    s_lshl_b32 s93, s54, 7
    v_add_u32 v23, s93, v23
    s_lshl_b32 s58, s54, 17
    s_add_u32 s58, s58, s40
    s_add_u32 s58, s58, 34603008
    s_lshl_b32 s93, s56, 10
    v_add_u32 v19, s93, v6
    v_xor_b32 v20, 1024, v19
    s_lshl_b32 s93, s56, 12
    v_add_u32 v21, s93, v6
    v_add_u32 v22, 65536, v21
    v_add_u32 v24, s40, v6
    v_add_u32 v24, 65536, v24
    v_xor_b32 v25, 16384, v24
    s_lshl_b32 s59, s33, 8
    s_add_u32 s59, s59, 33685504
    s_lshr_b32 s28, s53, 1
    s_lshl_b32 s28, s28, 8
    s_add_u32 s28, s28, 33685504
    v_lshrrev_b32 v4, 2, v1
    v_and_b32 v3, 3, v1
    s_and_b32 s93, s2, 7
    s_lshl_b32 s93, s93, 2
    s_lshr_b32 s94, s3, 1
    s_add_u32 s93, s93, s94
    s_lshl_b32 s93, s93, 5
    v_add_u32 v26, s93, v4
    v_lshlrev_b32 v26, 11, v26
    v_lshl_add_u32 v26, v3, 4, v26
    s_lshr_b32 s93, s2, 3
    s_and_b32 s93, s93, 15
    s_lshl_b32 s93, s93, 7
    s_and_b32 s94, s3, 1
    s_lshl_b32 s94, s94, 6
    s_add_u32 s93, s93, s94
    v_add_u32 v26, s93, v26
    v_lshrrev_b32 v3, 4, v1
    v_lshrrev_b32 v4, 1, v3
    v_lshlrev_b32 v4, 4, v4
    v_and_b32 v5, 1, v3
    v_lshl_add_u32 v4, v5, 2, v4
    v_lshrrev_b32 v5, 2, v1
    v_and_b32 v5, 3, v5
    v_add_u32 v4, v4, v5
    v_lshlrev_b32 v27, 6, v4
    v_and_b32 v4, 3, v1
    v_lshl_add_u32 v27, v4, 3, v27
    s_lshl_b32 s30, s3, 11
    s_add_u32 s93, s30, 131072
    v_add_u32 v27, s93, v27
    s_lshl_b32 s93, s2, 14
    s_add_u32 s30, s30, s93
    s_add_u32 s30, s30, 34603008
    v_and_b32 v28, 7, v1
    v_lshlrev_b32 v28, 8, v28
    v_add_u32 v28, 33689600, v28
    v_add_u32 v4, s50, v10
    v_subrev_u32 v180, 0, v4
    v_subrev_u32 v181, 1, v4
    v_subrev_u32 v182, 2, v4
    v_subrev_u32 v183, 3, v4
    v_cmp_gt_u32 s[60:61], s50, v180
    v_cmp_gt_u32 s[62:63], s50, v181
    v_cmp_gt_u32 s[64:65], s50, v182
    v_cmp_gt_u32 s[66:67], s50, v183
    s_nop 1
    v_cndmask_b32 v180, v11, v17, s[60:61]
    v_cndmask_b32 v181, v11, v17, s[62:63]
    v_cndmask_b32 v182, v11, v17, s[64:65]
    v_cndmask_b32 v183, v11, v17, s[66:67]
    v_subrev_u32 v184, 16, v4
    v_subrev_u32 v185, 17, v4
    v_subrev_u32 v186, 18, v4
    v_subrev_u32 v187, 19, v4
    v_cmp_gt_u32 s[60:61], s50, v184
    v_cmp_gt_u32 s[62:63], s50, v185
    v_cmp_gt_u32 s[64:65], s50, v186
    v_cmp_gt_u32 s[66:67], s50, v187
    s_nop 1
    v_cndmask_b32 v184, v11, v17, s[60:61]
    v_cndmask_b32 v185, v11, v17, s[62:63]
    v_cndmask_b32 v186, v11, v17, s[64:65]
    v_cndmask_b32 v187, v11, v17, s[66:67]
    v_subrev_u32 v188, 8, v4
    v_subrev_u32 v189, 9, v4
    v_subrev_u32 v190, 10, v4
    v_subrev_u32 v191, 11, v4
    v_cmp_gt_u32 s[60:61], s50, v188
    v_cmp_gt_u32 s[62:63], s50, v189
    v_cmp_gt_u32 s[64:65], s50, v190
    v_cmp_gt_u32 s[66:67], s50, v191
    s_nop 1
    v_cndmask_b32 v188, v11, v17, s[60:61]
    v_cndmask_b32 v189, v11, v17, s[62:63]
    v_cndmask_b32 v190, v11, v17, s[64:65]
    v_cndmask_b32 v191, v11, v17, s[66:67]
    v_subrev_u32 v192, 24, v4
    v_subrev_u32 v193, 25, v4
    v_subrev_u32 v194, 26, v4
    v_subrev_u32 v195, 27, v4
    v_cmp_gt_u32 s[60:61], s50, v192
    v_cmp_gt_u32 s[62:63], s50, v193
    v_cmp_gt_u32 s[64:65], s50, v194
    v_cmp_gt_u32 s[66:67], s50, v195
    s_nop 1
    v_cndmask_b32 v192, v11, v17, s[60:61]
    v_cndmask_b32 v193, v11, v17, s[62:63]
    v_cndmask_b32 v194, v11, v17, s[64:65]
    v_cndmask_b32 v195, v11, v17, s[66:67]
    v_sub_f32 v148, v11, v180
    v_sub_f32 v149, v11, v181
    v_sub_f32 v150, v11, v182
    v_sub_f32 v151, v11, v183
    v_sub_f32 v152, v11, v184
    v_sub_f32 v153, v11, v185
    v_sub_f32 v154, v11, v186
    v_sub_f32 v155, v11, v187
    v_sub_f32 v156, v11, v188
    v_sub_f32 v157, v11, v189
    v_sub_f32 v158, v11, v190
    v_sub_f32 v159, v11, v191
    v_sub_f32 v160, v11, v192
    v_sub_f32 v161, v11, v193
    v_sub_f32 v162, v11, v194
    v_sub_f32 v163, v11, v195
    s_sub_u32 s93, 8, s3
    s_cmp_eq_u32 s33, 0
    s_cselect_b32 s37, s93, 0
    s_cselect_b32 s93, 0xf149f2ca, 0
    v_mov_b32 v164, s93
    v_mov_b32 v165, s93
    v_mov_b32 v166, s93
    v_mov_b32 v167, s93
    v_mov_b32 v168, s93
    v_mov_b32 v169, s93
    v_mov_b32 v170, s93
    v_mov_b32 v171, s93
    v_mov_b32 v172, s93
    v_mov_b32 v173, s93
    v_mov_b32 v174, s93
    v_mov_b32 v175, s93
    v_mov_b32 v176, s93
    v_mov_b32 v177, s93
    v_mov_b32 v178, s93
    v_mov_b32 v179, s93
    v_add_f32 v180, s93, v180
    v_add_f32 v181, s93, v181
    v_add_f32 v182, s93, v182
    v_add_f32 v183, s93, v183
    v_add_f32 v184, s93, v184
    v_add_f32 v185, s93, v185
    v_add_f32 v186, s93, v186
    v_add_f32 v187, s93, v187
    v_add_f32 v188, s93, v188
    v_add_f32 v189, s93, v189
    v_add_f32 v190, s93, v190
    v_add_f32 v191, s93, v191
    v_add_f32 v192, s93, v192
    v_add_f32 v193, s93, v193
    v_add_f32 v194, s93, v194
    v_add_f32 v195, s93, v195
    s_waitcnt lgkmcnt(0)
    s_mov_b32 s24, s8
    s_mov_b32 s25, s9
    s_mov_b32 s26, 4194304
    s_mov_b32 s27, 0x00020000
    s_cmp_lt_u32 s2, 128
    s_cselect_b32 s4, s10, s14
    s_cselect_b32 s5, s11, s15
    s_mov_b32 s6, 2097152
    s_mov_b32 s7, 0x00020000
    s_waitcnt vmcnt(0)
    s_barrier
    ds_read_b128 v[44:47], v6 offset:0
    ds_read_b128 v[48:51], v6 offset:1024
    ds_read_b128 v[52:55], v6 offset:4096
    ds_read_b128 v[56:59], v6 offset:5120
    ds_read_b128 v[60:63], v6 offset:2048
    ds_read_b128 v[64:67], v6 offset:3072
    s_waitcnt lgkmcnt(4)
    v_mfma_f32_32x32x16_bf16 v[132:147], v[44:47], v[36:39], 0
    v_mfma_f32_32x32x16_bf16 v[132:147], v[48:51], v[40:43], v[132:147]
    ds_read_b128 v[44:47], v6 offset:8192
    ds_read_b128 v[48:51], v6 offset:9216
    s_nop 7
    s_nop 1
    s_setprio 3
    s_waitcnt lgkmcnt(2)
    v_mfma_f32_32x32x16_bf16 v[116:131], v[52:55], v[36:39], 0
    v_exp_f32 v132, v132
    v_exp_f32 v133, v133
    v_exp_f32 v134, v134
    v_mfma_f32_32x32x16_bf16 v[116:131], v[56:59], v[40:43], v[116:131]
    v_exp_f32 v135, v135
    v_exp_f32 v136, v136
    v_exp_f32 v137, v137
    ds_read_b128 v[52:55], v6 offset:12288
    ds_read_b128 v[56:59], v6 offset:13312
    v_exp_f32 v138, v138
    v_exp_f32 v139, v139
    v_cvt_pk_bf16_f32 v76, v132, v133
    v_cvt_pk_bf16_f32 v77, v134, v135
    v_exp_f32 v140, v140
    v_exp_f32 v141, v141
    v_cvt_pk_bf16_f32 v78, v136, v137
    v_cvt_pk_bf16_f32 v79, v138, v139
    ds_read_b128 v[68:71], v6 offset:6144
    ds_read_b128 v[72:75], v6 offset:7168
    s_add_u32 m0, s40, 32768
    s_add_u32 s93, s39, 32768
    buffer_load_dwordx4 v6, s[16:19], s93 offen offset:0 sc1 lds
    s_add_u32 m0, s40, 32768
    s_add_u32 s93, s39, 32768
    buffer_load_dwordx4 v6, s[16:19], s93 offen offset:1024 sc1 lds
    v_exp_f32 v142, v142
    v_exp_f32 v143, v143
    v_exp_f32 v144, v144
    v_exp_f32 v145, v145
    v_exp_f32 v146, v146
    v_exp_f32 v147, v147
    v_cvt_pk_bf16_f32 v80, v140, v141
    v_cvt_pk_bf16_f32 v81, v142, v143
    v_cvt_pk_bf16_f32 v82, v144, v145
    v_cvt_pk_bf16_f32 v83, v146, v147
    s_setprio 2
    s_waitcnt lgkmcnt(4)
    v_mfma_f32_32x32x16_bf16 v[132:147], v[44:47], v[36:39], 0
    v_exp_f32 v116, v116
    v_exp_f32 v117, v117
    v_exp_f32 v118, v118
    v_mfma_f32_32x32x16_bf16 v[132:147], v[48:51], v[40:43], v[132:147]
    v_exp_f32 v119, v119
    v_exp_f32 v120, v120
    v_exp_f32 v121, v121
    ds_read_b128 v[44:47], v6 offset:16384
    ds_read_b128 v[48:51], v6 offset:17408
    v_mfma_f32_32x32x16_bf16 v[100:115], v[60:63], v[76:79], 0
    v_exp_f32 v122, v122
    v_exp_f32 v123, v123
    v_cvt_pk_bf16_f32 v84, v116, v117
    v_cvt_pk_bf16_f32 v85, v118, v119
    v_mfma_f32_32x32x16_bf16 v[100:115], v[64:67], v[80:83], v[100:115]
    v_exp_f32 v124, v124
    v_exp_f32 v125, v125
    v_cvt_pk_bf16_f32 v86, v120, v121
    v_cvt_pk_bf16_f32 v87, v122, v123
    ds_read_b128 v[60:63], v6 offset:10240
    ds_read_b128 v[64:67], v6 offset:11264
    s_add_u32 m0, s40, 32768
    s_add_u32 s93, s39, 32768
    buffer_load_dwordx4 v6, s[16:19], s93 offen offset:2048 sc1 lds
    s_add_u32 m0, s40, 32768
    s_add_u32 s93, s39, 32768
    buffer_load_dwordx4 v6, s[16:19], s93 offen offset:3072 sc1 lds
    v_smfmac_f32_16x16x64_bf16 v[96:99], v[92:95], v[76:83], v16
    v_exp_f32 v126, v126
    v_exp_f32 v127, v127
    v_exp_f32 v128, v128
    v_exp_f32 v129, v129
    v_exp_f32 v130, v130
    v_exp_f32 v131, v131
    v_cvt_pk_bf16_f32 v88, v124, v125
    v_cvt_pk_bf16_f32 v89, v126, v127
    v_cvt_pk_bf16_f32 v90, v128, v129
    v_cvt_pk_bf16_f32 v91, v130, v131
    s_setprio 1
    s_waitcnt lgkmcnt(4)
    v_mfma_f32_32x32x16_bf16 v[116:131], v[52:55], v[36:39], 0
    v_exp_f32 v132, v132
    v_exp_f32 v133, v133
    v_exp_f32 v134, v134
    v_mfma_f32_32x32x16_bf16 v[116:131], v[56:59], v[40:43], v[116:131]
    v_exp_f32 v135, v135
    v_exp_f32 v136, v136
    v_exp_f32 v137, v137
    ds_read_b128 v[52:55], v6 offset:20480
    ds_read_b128 v[56:59], v6 offset:21504
    v_mfma_f32_32x32x16_bf16 v[100:115], v[68:71], v[84:87], v[100:115]
    v_exp_f32 v138, v138
    v_exp_f32 v139, v139
    v_cvt_pk_bf16_f32 v76, v132, v133
    v_cvt_pk_bf16_f32 v77, v134, v135
    v_mfma_f32_32x32x16_bf16 v[100:115], v[72:75], v[88:91], v[100:115]
    v_exp_f32 v140, v140
    v_exp_f32 v141, v141
    v_cvt_pk_bf16_f32 v78, v136, v137
    v_cvt_pk_bf16_f32 v79, v138, v139
    ds_read_b128 v[68:71], v6 offset:14336
    ds_read_b128 v[72:75], v6 offset:15360
    s_add_u32 m0, s40, 65536
    s_add_u32 s93, s39, 65536
    buffer_load_dwordx4 v6, s[16:19], s93 offen offset:0 sc1 lds
    v_smfmac_f32_16x16x64_bf16 v[96:99], v[92:95], v[84:91], v16
    v_exp_f32 v142, v142
    v_exp_f32 v143, v143
    v_exp_f32 v144, v144
    v_exp_f32 v145, v145
    v_exp_f32 v146, v146
    v_exp_f32 v147, v147
    v_cvt_pk_bf16_f32 v80, v140, v141
    v_cvt_pk_bf16_f32 v81, v142, v143
    v_cvt_pk_bf16_f32 v82, v144, v145
    v_cvt_pk_bf16_f32 v83, v146, v147
    s_setprio 0
    s_waitcnt lgkmcnt(4)
    v_mfma_f32_32x32x16_bf16 v[132:147], v[44:47], v[36:39], 0
    v_exp_f32 v116, v116
    v_exp_f32 v117, v117
    v_exp_f32 v118, v118
    v_mfma_f32_32x32x16_bf16 v[132:147], v[48:51], v[40:43], v[132:147]
    v_exp_f32 v119, v119
    v_exp_f32 v120, v120
    v_exp_f32 v121, v121
    ds_read_b128 v[44:47], v6 offset:24576
    ds_read_b128 v[48:51], v6 offset:25600
    v_mfma_f32_32x32x16_bf16 v[100:115], v[60:63], v[76:79], v[100:115]
    v_exp_f32 v122, v122
    v_exp_f32 v123, v123
    v_cvt_pk_bf16_f32 v84, v116, v117
    v_cvt_pk_bf16_f32 v85, v118, v119
    v_mfma_f32_32x32x16_bf16 v[100:115], v[64:67], v[80:83], v[100:115]
    v_exp_f32 v124, v124
    v_exp_f32 v125, v125
    v_cvt_pk_bf16_f32 v86, v120, v121
    v_cvt_pk_bf16_f32 v87, v122, v123
    ds_read_b128 v[60:63], v6 offset:18432
    ds_read_b128 v[64:67], v6 offset:19456
    s_add_u32 m0, s40, 65536
    s_add_u32 s93, s39, 65536
    buffer_load_dwordx4 v6, s[16:19], s93 offen offset:1024 sc1 lds
    buffer_store_dwordx4 v[200:203], v249, s[80:83], s85 offen offset:0 sc1
    v_smfmac_f32_16x16x64_bf16 v[96:99], v[92:95], v[76:83], v16
    v_exp_f32 v126, v126
    v_exp_f32 v127, v127
    v_exp_f32 v128, v128
    v_exp_f32 v129, v129
    v_exp_f32 v130, v130
    v_exp_f32 v131, v131
    v_cvt_pk_bf16_f32 v88, v124, v125
    v_cvt_pk_bf16_f32 v89, v126, v127
    v_cvt_pk_bf16_f32 v90, v128, v129
    v_cvt_pk_bf16_f32 v91, v130, v131
    s_waitcnt lgkmcnt(4)
    v_mfma_f32_32x32x16_bf16 v[116:131], v[52:55], v[36:39], 0
    v_exp_f32 v132, v132
    v_exp_f32 v133, v133
    v_exp_f32 v134, v134
    v_mfma_f32_32x32x16_bf16 v[116:131], v[56:59], v[40:43], v[116:131]
    v_exp_f32 v135, v135
    v_exp_f32 v136, v136
    v_exp_f32 v137, v137
    ds_read_b128 v[52:55], v6 offset:28672
    ds_read_b128 v[56:59], v6 offset:29696
    v_mfma_f32_32x32x16_bf16 v[100:115], v[68:71], v[84:87], v[100:115]
    v_exp_f32 v138, v138
    v_exp_f32 v139, v139
    v_cvt_pk_bf16_f32 v76, v132, v133
    v_cvt_pk_bf16_f32 v77, v134, v135
    v_mfma_f32_32x32x16_bf16 v[100:115], v[72:75], v[88:91], v[100:115]
    v_exp_f32 v140, v140
    v_exp_f32 v141, v141
    v_cvt_pk_bf16_f32 v78, v136, v137
    v_cvt_pk_bf16_f32 v79, v138, v139
    ds_read_b128 v[68:71], v6 offset:22528
    ds_read_b128 v[72:75], v6 offset:23552
    s_add_u32 m0, s40, 65536
    s_add_u32 s93, s39, 65536
    buffer_load_dwordx4 v6, s[16:19], s93 offen offset:2048 sc1 lds
    buffer_store_dwordx4 v[204:207], v249, s[80:83], s85 offen offset:128 sc1
    v_smfmac_f32_16x16x64_bf16 v[96:99], v[92:95], v[84:91], v16
    v_exp_f32 v142, v142
    v_exp_f32 v143, v143
    v_exp_f32 v144, v144
    v_exp_f32 v145, v145
    v_exp_f32 v146, v146
    v_exp_f32 v147, v147
    v_cvt_pk_bf16_f32 v80, v140, v141
    v_cvt_pk_bf16_f32 v81, v142, v143
    v_cvt_pk_bf16_f32 v82, v144, v145
    v_cvt_pk_bf16_f32 v83, v146, v147
    s_waitcnt vmcnt(5)
    s_barrier
    s_setprio 3
    s_waitcnt lgkmcnt(4)
    v_mfma_f32_32x32x16_bf16 v[132:147], v[44:47], v[36:39], 0
    v_exp_f32 v116, v116
    v_exp_f32 v117, v117
    v_exp_f32 v118, v118
    v_mfma_f32_32x32x16_bf16 v[132:147], v[48:51], v[40:43], v[132:147]
    v_exp_f32 v119, v119
    v_exp_f32 v120, v120
    v_exp_f32 v121, v121
    ds_read_b128 v[44:47], v6 offset:32768
    ds_read_b128 v[48:51], v6 offset:33792
    v_mfma_f32_32x32x16_bf16 v[100:115], v[60:63], v[76:79], v[100:115]
    v_exp_f32 v122, v122
    v_exp_f32 v123, v123
    v_cvt_pk_bf16_f32 v84, v116, v117
    v_cvt_pk_bf16_f32 v85, v118, v119
    v_mfma_f32_32x32x16_bf16 v[100:115], v[64:67], v[80:83], v[100:115]
    v_exp_f32 v124, v124
    v_exp_f32 v125, v125
    v_cvt_pk_bf16_f32 v86, v120, v121
    v_cvt_pk_bf16_f32 v87, v122, v123
    ds_read_b128 v[60:63], v6 offset:26624
    ds_read_b128 v[64:67], v6 offset:27648
    s_add_u32 m0, s40, 65536
    s_add_u32 s93, s39, 65536
    buffer_load_dwordx4 v6, s[16:19], s93 offen offset:3072 sc1 lds
    buffer_store_dwordx4 v[208:211], v249, s[80:83], s86 offen offset:0 sc1
    v_smfmac_f32_16x16x64_bf16 v[96:99], v[92:95], v[76:83], v16
    v_exp_f32 v126, v126
    v_exp_f32 v127, v127
    v_exp_f32 v128, v128
    v_exp_f32 v129, v129
    v_exp_f32 v130, v130
    v_exp_f32 v131, v131
    v_cvt_pk_bf16_f32 v88, v124, v125
    v_cvt_pk_bf16_f32 v89, v126, v127
    v_cvt_pk_bf16_f32 v90, v128, v129
    v_cvt_pk_bf16_f32 v91, v130, v131
    s_waitcnt lgkmcnt(4)
    v_mfma_f32_32x32x16_bf16 v[116:131], v[52:55], v[36:39], 0
    v_exp_f32 v132, v132
    v_exp_f32 v133, v133
    v_exp_f32 v134, v134
    v_mfma_f32_32x32x16_bf16 v[116:131], v[56:59], v[40:43], v[116:131]
    v_exp_f32 v135, v135
    v_exp_f32 v136, v136
    v_exp_f32 v137, v137
    ds_read_b128 v[52:55], v6 offset:36864
    ds_read_b128 v[56:59], v6 offset:37888
    v_mfma_f32_32x32x16_bf16 v[100:115], v[68:71], v[84:87], v[100:115]
    v_exp_f32 v138, v138
    v_exp_f32 v139, v139
    v_cvt_pk_bf16_f32 v76, v132, v133
    v_cvt_pk_bf16_f32 v77, v134, v135
    v_mfma_f32_32x32x16_bf16 v[100:115], v[72:75], v[88:91], v[100:115]
    v_exp_f32 v140, v140
    v_exp_f32 v141, v141
    v_cvt_pk_bf16_f32 v78, v136, v137
    v_cvt_pk_bf16_f32 v79, v138, v139
    ds_read_b128 v[68:71], v6 offset:30720
    ds_read_b128 v[72:75], v6 offset:31744
    buffer_store_dwordx4 v[212:215], v249, s[80:83], s86 offen offset:128 sc1
    s_add_u32 m0, s40, 98304
    s_add_u32 s93, s39, 98304
    buffer_load_dwordx4 v6, s[16:19], s93 offen offset:0 sc1 lds
    v_smfmac_f32_16x16x64_bf16 v[96:99], v[92:95], v[84:91], v16
    v_exp_f32 v142, v142
    v_exp_f32 v143, v143
    v_exp_f32 v144, v144
    v_exp_f32 v145, v145
    v_exp_f32 v146, v146
    v_exp_f32 v147, v147
    v_cvt_pk_bf16_f32 v80, v140, v141
    v_cvt_pk_bf16_f32 v81, v142, v143
    v_cvt_pk_bf16_f32 v82, v144, v145
    v_cvt_pk_bf16_f32 v83, v146, v147
    s_setprio 2
    s_waitcnt lgkmcnt(4)
    v_mfma_f32_32x32x16_bf16 v[132:147], v[44:47], v[36:39], 0
    v_exp_f32 v116, v116
    v_exp_f32 v117, v117
    v_exp_f32 v118, v118
    v_mfma_f32_32x32x16_bf16 v[132:147], v[48:51], v[40:43], v[132:147]
    v_exp_f32 v119, v119
    v_exp_f32 v120, v120
    v_exp_f32 v121, v121
    ds_read_b128 v[44:47], v6 offset:40960
    ds_read_b128 v[48:51], v6 offset:41984
    v_mfma_f32_32x32x16_bf16 v[100:115], v[60:63], v[76:79], v[100:115]
    v_exp_f32 v122, v122
    v_exp_f32 v123, v123
    v_cvt_pk_bf16_f32 v84, v116, v117
    v_cvt_pk_bf16_f32 v85, v118, v119
    v_mfma_f32_32x32x16_bf16 v[100:115], v[64:67], v[80:83], v[100:115]
    v_exp_f32 v124, v124
    v_exp_f32 v125, v125
    v_cvt_pk_bf16_f32 v86, v120, v121
    v_cvt_pk_bf16_f32 v87, v122, v123
    ds_read_b128 v[60:63], v6 offset:34816
    ds_read_b128 v[64:67], v6 offset:35840
    buffer_store_dwordx4 v[216:219], v248, s[80:83], s87 offen offset:2048 sc1
    v_smfmac_f32_16x16x64_bf16 v[96:99], v[92:95], v[76:83], v16
    v_exp_f32 v126, v126
    v_exp_f32 v127, v127
    v_exp_f32 v128, v128
    v_exp_f32 v129, v129
    v_exp_f32 v130, v130
    v_exp_f32 v131, v131
    v_cvt_pk_bf16_f32 v88, v124, v125
    v_cvt_pk_bf16_f32 v89, v126, v127
    v_cvt_pk_bf16_f32 v90, v128, v129
    v_cvt_pk_bf16_f32 v91, v130, v131
    s_waitcnt lgkmcnt(4)
    v_mfma_f32_32x32x16_bf16 v[116:131], v[52:55], v[36:39], 0
    v_exp_f32 v132, v132
    v_exp_f32 v133, v133
    v_exp_f32 v134, v134
    v_mfma_f32_32x32x16_bf16 v[116:131], v[56:59], v[40:43], v[116:131]
    v_exp_f32 v135, v135
    v_exp_f32 v136, v136
    v_exp_f32 v137, v137
    ds_read_b128 v[52:55], v6 offset:45056
    ds_read_b128 v[56:59], v6 offset:46080
    v_mfma_f32_32x32x16_bf16 v[100:115], v[68:71], v[84:87], v[100:115]
    v_exp_f32 v138, v138
    v_exp_f32 v139, v139
    v_cvt_pk_bf16_f32 v76, v132, v133
    v_cvt_pk_bf16_f32 v77, v134, v135
    v_mfma_f32_32x32x16_bf16 v[100:115], v[72:75], v[88:91], v[100:115]
    v_exp_f32 v140, v140
    v_exp_f32 v141, v141
    v_cvt_pk_bf16_f32 v78, v136, v137
    v_cvt_pk_bf16_f32 v79, v138, v139
    ds_read_b128 v[68:71], v6 offset:38912
    ds_read_b128 v[72:75], v6 offset:39936
    buffer_store_dwordx4 v[220:223], v248, s[80:83], s87 offen offset:2304 sc1
    s_add_u32 m0, s40, 98304
    s_add_u32 s93, s39, 98304
    buffer_load_dwordx4 v6, s[16:19], s93 offen offset:1024 sc1 lds
    v_smfmac_f32_16x16x64_bf16 v[96:99], v[92:95], v[84:91], v16
    v_exp_f32 v142, v142
    v_exp_f32 v143, v143
    v_exp_f32 v144, v144
    v_exp_f32 v145, v145
    v_exp_f32 v146, v146
    v_exp_f32 v147, v147
    v_cvt_pk_bf16_f32 v80, v140, v141
    v_cvt_pk_bf16_f32 v81, v142, v143
    v_cvt_pk_bf16_f32 v82, v144, v145
    v_cvt_pk_bf16_f32 v83, v146, v147
    s_setprio 1
    s_waitcnt lgkmcnt(4)
    v_mfma_f32_32x32x16_bf16 v[132:147], v[44:47], v[36:39], 0
    v_exp_f32 v116, v116
    v_exp_f32 v117, v117
    v_exp_f32 v118, v118
    v_mfma_f32_32x32x16_bf16 v[132:147], v[48:51], v[40:43], v[132:147]
    v_exp_f32 v119, v119
    v_exp_f32 v120, v120
    v_exp_f32 v121, v121
    ds_read_b128 v[44:47], v6 offset:49152
    ds_read_b128 v[48:51], v6 offset:50176
    v_mfma_f32_32x32x16_bf16 v[100:115], v[60:63], v[76:79], v[100:115]
    v_exp_f32 v122, v122
    v_exp_f32 v123, v123
    v_cvt_pk_bf16_f32 v84, v116, v117
    v_cvt_pk_bf16_f32 v85, v118, v119
    v_mfma_f32_32x32x16_bf16 v[100:115], v[64:67], v[80:83], v[100:115]
    v_exp_f32 v124, v124
    v_exp_f32 v125, v125
    v_cvt_pk_bf16_f32 v86, v120, v121
    v_cvt_pk_bf16_f32 v87, v122, v123
    ds_read_b128 v[60:63], v6 offset:43008
    ds_read_b128 v[64:67], v6 offset:44032
    buffer_store_dwordx4 v[224:227], v248, s[80:83], s88 offen offset:2048 sc1
    v_smfmac_f32_16x16x64_bf16 v[96:99], v[92:95], v[76:83], v16
    v_exp_f32 v126, v126
    v_exp_f32 v127, v127
    v_exp_f32 v128, v128
    v_exp_f32 v129, v129
    v_exp_f32 v130, v130
    v_exp_f32 v131, v131
    v_cvt_pk_bf16_f32 v88, v124, v125
    v_cvt_pk_bf16_f32 v89, v126, v127
    v_cvt_pk_bf16_f32 v90, v128, v129
    v_cvt_pk_bf16_f32 v91, v130, v131
    s_waitcnt lgkmcnt(4)
    v_mfma_f32_32x32x16_bf16 v[116:131], v[52:55], v[36:39], 0
    v_exp_f32 v132, v132
    v_exp_f32 v133, v133
    v_exp_f32 v134, v134
    v_mfma_f32_32x32x16_bf16 v[116:131], v[56:59], v[40:43], v[116:131]
    v_exp_f32 v135, v135
    v_exp_f32 v136, v136
    v_exp_f32 v137, v137
    ds_read_b128 v[52:55], v6 offset:53248
    ds_read_b128 v[56:59], v6 offset:54272
    v_mfma_f32_32x32x16_bf16 v[100:115], v[68:71], v[84:87], v[100:115]
    v_exp_f32 v138, v138
    v_exp_f32 v139, v139
    v_cvt_pk_bf16_f32 v76, v132, v133
    v_cvt_pk_bf16_f32 v77, v134, v135
    v_mfma_f32_32x32x16_bf16 v[100:115], v[72:75], v[88:91], v[100:115]
    v_exp_f32 v140, v140
    v_exp_f32 v141, v141
    v_cvt_pk_bf16_f32 v78, v136, v137
    v_cvt_pk_bf16_f32 v79, v138, v139
    ds_read_b128 v[68:71], v6 offset:47104
    ds_read_b128 v[72:75], v6 offset:48128
    buffer_store_dwordx4 v[228:231], v248, s[80:83], s88 offen offset:2304 sc1
    s_add_u32 m0, s40, 98304
    s_add_u32 s93, s39, 98304
    buffer_load_dwordx4 v6, s[16:19], s93 offen offset:2048 sc1 lds
    v_smfmac_f32_16x16x64_bf16 v[96:99], v[92:95], v[84:91], v16
    v_exp_f32 v142, v142
    v_exp_f32 v143, v143
    v_exp_f32 v144, v144
    v_exp_f32 v145, v145
    v_exp_f32 v146, v146
    v_exp_f32 v147, v147
    v_cvt_pk_bf16_f32 v80, v140, v141
    v_cvt_pk_bf16_f32 v81, v142, v143
    v_cvt_pk_bf16_f32 v82, v144, v145
    v_cvt_pk_bf16_f32 v83, v146, v147
    s_setprio 0
    s_waitcnt lgkmcnt(4)
    v_mfma_f32_32x32x16_bf16 v[132:147], v[44:47], v[36:39], 0
    v_exp_f32 v116, v116
    v_exp_f32 v117, v117
    v_exp_f32 v118, v118
    v_mfma_f32_32x32x16_bf16 v[132:147], v[48:51], v[40:43], v[132:147]
    v_exp_f32 v119, v119
    v_exp_f32 v120, v120
    v_exp_f32 v121, v121
    ds_read_b128 v[44:47], v6 offset:57344
    ds_read_b128 v[48:51], v6 offset:58368
    v_mfma_f32_32x32x16_bf16 v[100:115], v[60:63], v[76:79], v[100:115]
    v_exp_f32 v122, v122
    v_exp_f32 v123, v123
    v_cvt_pk_bf16_f32 v84, v116, v117
    v_cvt_pk_bf16_f32 v85, v118, v119
    v_mfma_f32_32x32x16_bf16 v[100:115], v[64:67], v[80:83], v[100:115]
    v_exp_f32 v124, v124
    v_exp_f32 v125, v125
    v_cvt_pk_bf16_f32 v86, v120, v121
    v_cvt_pk_bf16_f32 v87, v122, v123
    ds_read_b128 v[60:63], v6 offset:51200
    ds_read_b128 v[64:67], v6 offset:52224
    buffer_store_dwordx4 v[232:235], v248, s[80:83], s84 offen offset:0 sc1
    v_smfmac_f32_16x16x64_bf16 v[96:99], v[92:95], v[76:83], v16
    v_exp_f32 v126, v126
    v_exp_f32 v127, v127
    v_exp_f32 v128, v128
    v_exp_f32 v129, v129
    v_exp_f32 v130, v130
    v_exp_f32 v131, v131
    v_cvt_pk_bf16_f32 v88, v124, v125
    v_cvt_pk_bf16_f32 v89, v126, v127
    v_cvt_pk_bf16_f32 v90, v128, v129
    v_cvt_pk_bf16_f32 v91, v130, v131
    s_waitcnt lgkmcnt(4)
    v_mfma_f32_32x32x16_bf16 v[116:131], v[52:55], v[36:39], 0
    v_exp_f32 v132, v132
    v_exp_f32 v133, v133
    v_exp_f32 v134, v134
    v_mfma_f32_32x32x16_bf16 v[116:131], v[56:59], v[40:43], v[116:131]
    v_exp_f32 v135, v135
    v_exp_f32 v136, v136
    v_exp_f32 v137, v137
    ds_read_b128 v[52:55], v6 offset:61440
    ds_read_b128 v[56:59], v6 offset:62464
    v_mfma_f32_32x32x16_bf16 v[100:115], v[68:71], v[84:87], v[100:115]
    v_exp_f32 v138, v138
    v_exp_f32 v139, v139
    v_cvt_pk_bf16_f32 v76, v132, v133
    v_cvt_pk_bf16_f32 v77, v134, v135
    v_mfma_f32_32x32x16_bf16 v[100:115], v[72:75], v[88:91], v[100:115]
    v_exp_f32 v140, v140
    v_exp_f32 v141, v141
    v_cvt_pk_bf16_f32 v78, v136, v137
    v_cvt_pk_bf16_f32 v79, v138, v139
    ds_read_b128 v[68:71], v6 offset:55296
    ds_read_b128 v[72:75], v6 offset:56320
    buffer_store_dwordx4 v[236:239], v248, s[80:83], s84 offen offset:256 sc1
    s_add_u32 m0, s40, 98304
    s_add_u32 s93, s39, 98304
    buffer_load_dwordx4 v6, s[16:19], s93 offen offset:3072 sc1 lds
    v_smfmac_f32_16x16x64_bf16 v[96:99], v[92:95], v[84:91], v16
    v_exp_f32 v142, v142
    v_exp_f32 v143, v143
    v_exp_f32 v144, v144
    v_exp_f32 v145, v145
    v_exp_f32 v146, v146
    v_exp_f32 v147, v147
    v_cvt_pk_bf16_f32 v80, v140, v141
    v_cvt_pk_bf16_f32 v81, v142, v143
    v_cvt_pk_bf16_f32 v82, v144, v145
    v_cvt_pk_bf16_f32 v83, v146, v147
    s_waitcnt vmcnt(12)
    s_barrier
    s_setprio 3
    s_waitcnt lgkmcnt(4)
    v_mfma_f32_32x32x16_bf16 v[132:147], v[44:47], v[36:39], 0
    v_exp_f32 v116, v116
    v_exp_f32 v117, v117
    v_exp_f32 v118, v118
    v_mfma_f32_32x32x16_bf16 v[132:147], v[48:51], v[40:43], v[132:147]
    v_exp_f32 v119, v119
    v_exp_f32 v120, v120
    v_exp_f32 v121, v121
    ds_read_b128 v[44:47], v7 offset:0
    ds_read_b128 v[48:51], v7 offset:1024
    v_mfma_f32_32x32x16_bf16 v[100:115], v[60:63], v[76:79], v[100:115]
    v_exp_f32 v122, v122
    v_exp_f32 v123, v123
    v_cvt_pk_bf16_f32 v84, v116, v117
    v_cvt_pk_bf16_f32 v85, v118, v119
    v_mfma_f32_32x32x16_bf16 v[100:115], v[64:67], v[80:83], v[100:115]
    v_exp_f32 v124, v124
    v_exp_f32 v125, v125
    v_cvt_pk_bf16_f32 v86, v120, v121
    v_cvt_pk_bf16_f32 v87, v122, v123
    ds_read_b128 v[60:63], v6 offset:59392
    ds_read_b128 v[64:67], v6 offset:60416
    buffer_store_dwordx4 v[240:243], v248, s[80:83], s84 offen offset:2048 sc1
    v_smfmac_f32_16x16x64_bf16 v[96:99], v[92:95], v[76:83], v16
    v_exp_f32 v126, v126
    v_exp_f32 v127, v127
    v_exp_f32 v128, v128
    v_exp_f32 v129, v129
    v_exp_f32 v130, v130
    v_exp_f32 v131, v131
    v_cvt_pk_bf16_f32 v88, v124, v125
    v_cvt_pk_bf16_f32 v89, v126, v127
    v_cvt_pk_bf16_f32 v90, v128, v129
    v_cvt_pk_bf16_f32 v91, v130, v131
    s_waitcnt lgkmcnt(4)
    v_mfma_f32_32x32x16_bf16 v[116:131], v[52:55], v[36:39], 0
    v_exp_f32 v132, v132
    v_exp_f32 v133, v133
    v_exp_f32 v134, v134
    v_mfma_f32_32x32x16_bf16 v[116:131], v[56:59], v[40:43], v[116:131]
    v_exp_f32 v135, v135
    v_exp_f32 v136, v136
    v_exp_f32 v137, v137
    ds_read_b128 v[52:55], v7 offset:4096
    ds_read_b128 v[56:59], v7 offset:5120
    v_mfma_f32_32x32x16_bf16 v[100:115], v[68:71], v[84:87], v[100:115]
    v_exp_f32 v138, v138
    v_exp_f32 v139, v139
    v_cvt_pk_bf16_f32 v76, v132, v133
    v_cvt_pk_bf16_f32 v77, v134, v135
    v_mfma_f32_32x32x16_bf16 v[100:115], v[72:75], v[88:91], v[100:115]
    v_exp_f32 v140, v140
    v_exp_f32 v141, v141
    v_cvt_pk_bf16_f32 v78, v136, v137
    v_cvt_pk_bf16_f32 v79, v138, v139
    ds_read_b128 v[68:71], v6 offset:63488
    ds_read_b128 v[72:75], v6 offset:64512
    buffer_store_dwordx4 v[244:247], v248, s[80:83], s84 offen offset:2304 sc1
    v_smfmac_f32_16x16x64_bf16 v[96:99], v[92:95], v[84:91], v16
    v_exp_f32 v142, v142
    v_exp_f32 v143, v143
    v_exp_f32 v144, v144
    v_exp_f32 v145, v145
    v_exp_f32 v146, v146
    v_exp_f32 v147, v147
    v_cvt_pk_bf16_f32 v80, v140, v141
    v_cvt_pk_bf16_f32 v81, v142, v143
    v_cvt_pk_bf16_f32 v82, v144, v145
    v_cvt_pk_bf16_f32 v83, v146, v147
    s_setprio 2
    s_waitcnt lgkmcnt(4)
    v_mfma_f32_32x32x16_bf16 v[132:147], v[44:47], v[36:39], 0
    v_exp_f32 v116, v116
    v_exp_f32 v117, v117
    v_exp_f32 v118, v118
    v_mfma_f32_32x32x16_bf16 v[132:147], v[48:51], v[40:43], v[132:147]
    v_exp_f32 v119, v119
    v_exp_f32 v120, v120
    v_exp_f32 v121, v121
    ds_read_b128 v[44:47], v7 offset:8192
    ds_read_b128 v[48:51], v7 offset:9216
    v_mfma_f32_32x32x16_bf16 v[100:115], v[60:63], v[76:79], v[100:115]
    v_exp_f32 v122, v122
    v_exp_f32 v123, v123
    v_cvt_pk_bf16_f32 v84, v116, v117
    v_cvt_pk_bf16_f32 v85, v118, v119
    v_mfma_f32_32x32x16_bf16 v[100:115], v[64:67], v[80:83], v[100:115]
    v_exp_f32 v124, v124
    v_exp_f32 v125, v125
    v_cvt_pk_bf16_f32 v86, v120, v121
    v_cvt_pk_bf16_f32 v87, v122, v123
    ds_read_b128 v[60:63], v7 offset:2048
    ds_read_b128 v[64:67], v7 offset:3072
    s_mov_b32 exec_lo, 0
    s_mov_b32 exec_hi, 0x80000000
    buffer_store_dword v251, v17, s[16:19], s90 offen sc1
    buffer_store_dword v252, v17, s[16:19], s91 offen sc1
    s_mov_b64 exec, -1
    v_smfmac_f32_16x16x64_bf16 v[96:99], v[92:95], v[76:83], v16
    v_exp_f32 v126, v126
    v_exp_f32 v127, v127
    v_exp_f32 v128, v128
    v_exp_f32 v129, v129
    v_exp_f32 v130, v130
    v_exp_f32 v131, v131
    v_cvt_pk_bf16_f32 v88, v124, v125
    v_cvt_pk_bf16_f32 v89, v126, v127
    v_cvt_pk_bf16_f32 v90, v128, v129
    v_cvt_pk_bf16_f32 v91, v130, v131
    s_waitcnt lgkmcnt(4)
    v_mfma_f32_32x32x16_bf16 v[116:131], v[52:55], v[36:39], 0
    v_exp_f32 v132, v132
    v_exp_f32 v133, v133
    v_exp_f32 v134, v134
    v_mfma_f32_32x32x16_bf16 v[116:131], v[56:59], v[40:43], v[116:131]
    v_exp_f32 v135, v135
    v_exp_f32 v136, v136
    v_exp_f32 v137, v137
    ds_read_b128 v[52:55], v7 offset:12288
    ds_read_b128 v[56:59], v7 offset:13312
    v_mfma_f32_32x32x16_bf16 v[100:115], v[68:71], v[84:87], v[100:115]
    v_exp_f32 v138, v138
    v_exp_f32 v139, v139
    v_cvt_pk_bf16_f32 v76, v132, v133
    v_cvt_pk_bf16_f32 v77, v134, v135
    v_mfma_f32_32x32x16_bf16 v[100:115], v[72:75], v[88:91], v[100:115]
    v_exp_f32 v140, v140
    v_exp_f32 v141, v141
    v_cvt_pk_bf16_f32 v78, v136, v137
    v_cvt_pk_bf16_f32 v79, v138, v139
    ds_read_b128 v[68:71], v7 offset:6144
    ds_read_b128 v[72:75], v7 offset:7168
    s_add_u32 m0, s40, 0
    s_add_u32 s93, s39, 131072
    buffer_load_dwordx4 v6, s[16:19], s93 offen offset:0 sc1 lds
    v_smfmac_f32_16x16x64_bf16 v[96:99], v[92:95], v[84:91], v16
    v_exp_f32 v142, v142
    v_exp_f32 v143, v143
    v_exp_f32 v144, v144
    v_exp_f32 v145, v145
    v_exp_f32 v146, v146
    v_exp_f32 v147, v147
    v_cvt_pk_bf16_f32 v80, v140, v141
    v_cvt_pk_bf16_f32 v81, v142, v143
    v_cvt_pk_bf16_f32 v82, v144, v145
    v_cvt_pk_bf16_f32 v83, v146, v147
    s_setprio 1
    s_waitcnt lgkmcnt(4)
    v_mfma_f32_32x32x16_bf16 v[132:147], v[44:47], v[36:39], 0
    v_exp_f32 v116, v116
    v_exp_f32 v117, v117
    v_exp_f32 v118, v118
    v_mfma_f32_32x32x16_bf16 v[132:147], v[48:51], v[40:43], v[132:147]
    v_exp_f32 v119, v119
    v_exp_f32 v120, v120
    v_exp_f32 v121, v121
    ds_read_b128 v[44:47], v7 offset:16384
    ds_read_b128 v[48:51], v7 offset:17408
    v_mfma_f32_32x32x16_bf16 v[100:115], v[60:63], v[76:79], v[100:115]
    v_exp_f32 v122, v122
    v_exp_f32 v123, v123
    v_cvt_pk_bf16_f32 v84, v116, v117
    v_cvt_pk_bf16_f32 v85, v118, v119
    v_mfma_f32_32x32x16_bf16 v[100:115], v[64:67], v[80:83], v[100:115]
    v_exp_f32 v124, v124
    v_exp_f32 v125, v125
    v_cvt_pk_bf16_f32 v86, v120, v121
    v_cvt_pk_bf16_f32 v87, v122, v123
    ds_read_b128 v[60:63], v7 offset:10240
    ds_read_b128 v[64:67], v7 offset:11264
    s_add_u32 m0, s40, 0
    s_add_u32 s93, s39, 131072
    buffer_load_dwordx4 v6, s[16:19], s93 offen offset:1024 sc1 lds
    v_smfmac_f32_16x16x64_bf16 v[96:99], v[92:95], v[76:83], v16
    v_exp_f32 v126, v126
    v_exp_f32 v127, v127
    v_exp_f32 v128, v128
    v_exp_f32 v129, v129
    v_exp_f32 v130, v130
    v_exp_f32 v131, v131
    v_cvt_pk_bf16_f32 v88, v124, v125
    v_cvt_pk_bf16_f32 v89, v126, v127
    v_cvt_pk_bf16_f32 v90, v128, v129
    v_cvt_pk_bf16_f32 v91, v130, v131
    s_waitcnt lgkmcnt(4)
    v_mfma_f32_32x32x16_bf16 v[116:131], v[52:55], v[36:39], 0
    v_exp_f32 v132, v132
    v_exp_f32 v133, v133
    v_exp_f32 v134, v134
    v_mfma_f32_32x32x16_bf16 v[116:131], v[56:59], v[40:43], v[116:131]
    v_exp_f32 v135, v135
    v_exp_f32 v136, v136
    v_exp_f32 v137, v137
    ds_read_b128 v[52:55], v7 offset:20480
    ds_read_b128 v[56:59], v7 offset:21504
    v_mfma_f32_32x32x16_bf16 v[100:115], v[68:71], v[84:87], v[100:115]
    v_exp_f32 v138, v138
    v_exp_f32 v139, v139
    v_cvt_pk_bf16_f32 v76, v132, v133
    v_cvt_pk_bf16_f32 v77, v134, v135
    v_mfma_f32_32x32x16_bf16 v[100:115], v[72:75], v[88:91], v[100:115]
    v_exp_f32 v140, v140
    v_exp_f32 v141, v141
    v_cvt_pk_bf16_f32 v78, v136, v137
    v_cvt_pk_bf16_f32 v79, v138, v139
    ds_read_b128 v[68:71], v7 offset:14336
    ds_read_b128 v[72:75], v7 offset:15360
    s_add_u32 m0, s40, 0
    s_add_u32 s93, s39, 131072
    buffer_load_dwordx4 v6, s[16:19], s93 offen offset:2048 sc1 lds
    v_smfmac_f32_16x16x64_bf16 v[96:99], v[92:95], v[84:91], v16
    v_exp_f32 v142, v142
    v_exp_f32 v143, v143
    v_exp_f32 v144, v144
    v_exp_f32 v145, v145
    v_exp_f32 v146, v146
    v_exp_f32 v147, v147
    v_cvt_pk_bf16_f32 v80, v140, v141
    v_cvt_pk_bf16_f32 v81, v142, v143
    v_cvt_pk_bf16_f32 v82, v144, v145
    v_cvt_pk_bf16_f32 v83, v146, v147
    s_setprio 0
    s_waitcnt lgkmcnt(4)
    v_mfma_f32_32x32x16_bf16 v[132:147], v[44:47], v[36:39], 0
    v_exp_f32 v116, v116
    v_exp_f32 v117, v117
    v_exp_f32 v118, v118
    v_mfma_f32_32x32x16_bf16 v[132:147], v[48:51], v[40:43], v[132:147]
    v_exp_f32 v119, v119
    v_exp_f32 v120, v120
    v_exp_f32 v121, v121
    ds_read_b128 v[44:47], v7 offset:24576
    ds_read_b128 v[48:51], v7 offset:25600
    v_mfma_f32_32x32x16_bf16 v[100:115], v[60:63], v[76:79], v[100:115]
    v_exp_f32 v122, v122
    v_exp_f32 v123, v123
    v_cvt_pk_bf16_f32 v84, v116, v117
    v_cvt_pk_bf16_f32 v85, v118, v119
    v_mfma_f32_32x32x16_bf16 v[100:115], v[64:67], v[80:83], v[100:115]
    v_exp_f32 v124, v124
    v_exp_f32 v125, v125
    v_cvt_pk_bf16_f32 v86, v120, v121
    v_cvt_pk_bf16_f32 v87, v122, v123
    ds_read_b128 v[60:63], v7 offset:18432
    ds_read_b128 v[64:67], v7 offset:19456
    s_add_u32 m0, s40, 0
    s_add_u32 s93, s39, 131072
    buffer_load_dwordx4 v6, s[16:19], s93 offen offset:3072 sc1 lds
    v_smfmac_f32_16x16x64_bf16 v[96:99], v[92:95], v[76:83], v16
    v_exp_f32 v126, v126
    v_exp_f32 v127, v127
    v_exp_f32 v128, v128
    v_exp_f32 v129, v129
    v_exp_f32 v130, v130
    v_exp_f32 v131, v131
    v_cvt_pk_bf16_f32 v88, v124, v125
    v_cvt_pk_bf16_f32 v89, v126, v127
    v_cvt_pk_bf16_f32 v90, v128, v129
    v_cvt_pk_bf16_f32 v91, v130, v131
    s_waitcnt lgkmcnt(4)
    v_mfma_f32_32x32x16_bf16 v[116:131], v[52:55], v[36:39], 0
    v_exp_f32 v132, v132
    v_exp_f32 v133, v133
    v_exp_f32 v134, v134
    v_mfma_f32_32x32x16_bf16 v[116:131], v[56:59], v[40:43], v[116:131]
    v_exp_f32 v135, v135
    v_exp_f32 v136, v136
    v_exp_f32 v137, v137
    ds_read_b128 v[52:55], v7 offset:28672
    ds_read_b128 v[56:59], v7 offset:29696
    v_mfma_f32_32x32x16_bf16 v[100:115], v[68:71], v[84:87], v[100:115]
    v_exp_f32 v138, v138
    v_exp_f32 v139, v139
    v_cvt_pk_bf16_f32 v76, v132, v133
    v_cvt_pk_bf16_f32 v77, v134, v135
    v_mfma_f32_32x32x16_bf16 v[100:115], v[72:75], v[88:91], v[100:115]
    v_exp_f32 v140, v140
    v_exp_f32 v141, v141
    v_cvt_pk_bf16_f32 v78, v136, v137
    v_cvt_pk_bf16_f32 v79, v138, v139
    ds_read_b128 v[68:71], v7 offset:22528
    ds_read_b128 v[72:75], v7 offset:23552
    v_smfmac_f32_16x16x64_bf16 v[96:99], v[92:95], v[84:91], v16
    v_exp_f32 v142, v142
    v_exp_f32 v143, v143
    v_exp_f32 v144, v144
    v_exp_f32 v145, v145
    v_exp_f32 v146, v146
    v_exp_f32 v147, v147
    v_cvt_pk_bf16_f32 v80, v140, v141
    v_cvt_pk_bf16_f32 v81, v142, v143
    v_cvt_pk_bf16_f32 v82, v144, v145
    v_cvt_pk_bf16_f32 v83, v146, v147
    s_waitcnt vmcnt(4)
    s_barrier
    s_setprio 3
    s_waitcnt lgkmcnt(4)
    v_mfma_f32_32x32x16_bf16 v[132:147], v[44:47], v[36:39], 0
    v_exp_f32 v116, v116
    v_exp_f32 v117, v117
    v_exp_f32 v118, v118
    v_mfma_f32_32x32x16_bf16 v[132:147], v[48:51], v[40:43], v[132:147]
    v_exp_f32 v119, v119
    v_exp_f32 v120, v120
    v_exp_f32 v121, v121
    ds_read_b128 v[44:47], v7 offset:32768
    ds_read_b128 v[48:51], v7 offset:33792
    v_mfma_f32_32x32x16_bf16 v[100:115], v[60:63], v[76:79], v[100:115]
    v_exp_f32 v122, v122
    v_exp_f32 v123, v123
    v_cvt_pk_bf16_f32 v84, v116, v117
    v_cvt_pk_bf16_f32 v85, v118, v119
    v_mfma_f32_32x32x16_bf16 v[100:115], v[64:67], v[80:83], v[100:115]
    v_exp_f32 v124, v124
    v_exp_f32 v125, v125
    v_cvt_pk_bf16_f32 v86, v120, v121
    v_cvt_pk_bf16_f32 v87, v122, v123
    ds_read_b128 v[60:63], v7 offset:26624
    ds_read_b128 v[64:67], v7 offset:27648
    s_cmp_eq_u32 s3, 0
    s_cbranch_scc0 L_w1
    s_mov_b64 exec, 1
    buffer_store_dword v18, v17, s[16:19], s92 offen offset:64 sc1
    s_mov_b64 exec, -1
L_w1:
    s_lshl_b32 s93, s3, 11
    s_add_u32 m0, s93, 131072
    s_mov_b32 s94, 32768
    buffer_load_dwordx4 v26, s[4:7], 0 offen lds
    v_smfmac_f32_16x16x64_bf16 v[96:99], v[92:95], v[76:83], v16
    v_exp_f32 v126, v126
    v_exp_f32 v127, v127
    v_exp_f32 v128, v128
    v_exp_f32 v129, v129
    v_exp_f32 v130, v130
    v_exp_f32 v131, v131
    v_cvt_pk_bf16_f32 v88, v124, v125
    v_cvt_pk_bf16_f32 v89, v126, v127
    v_cvt_pk_bf16_f32 v90, v128, v129
    v_cvt_pk_bf16_f32 v91, v130, v131
    s_waitcnt lgkmcnt(4)
    v_mfma_f32_32x32x16_bf16 v[116:131], v[52:55], v[36:39], 0
    v_exp_f32 v132, v132
    v_exp_f32 v133, v133
    v_exp_f32 v134, v134
    v_mfma_f32_32x32x16_bf16 v[116:131], v[56:59], v[40:43], v[116:131]
    v_exp_f32 v135, v135
    v_exp_f32 v136, v136
    v_exp_f32 v137, v137
    ds_read_b128 v[52:55], v7 offset:36864
    ds_read_b128 v[56:59], v7 offset:37888
    v_mfma_f32_32x32x16_bf16 v[100:115], v[68:71], v[84:87], v[100:115]
    v_exp_f32 v138, v138
    v_exp_f32 v139, v139
    v_cvt_pk_bf16_f32 v76, v132, v133
    v_cvt_pk_bf16_f32 v77, v134, v135
    v_mfma_f32_32x32x16_bf16 v[100:115], v[72:75], v[88:91], v[100:115]
    v_exp_f32 v140, v140
    v_exp_f32 v141, v141
    v_cvt_pk_bf16_f32 v78, v136, v137
    v_cvt_pk_bf16_f32 v79, v138, v139
    ds_read_b128 v[68:71], v7 offset:30720
    ds_read_b128 v[72:75], v7 offset:31744
    s_lshl_b32 s93, s3, 11
    s_mov_b32 s94, 32768
    s_add_u32 m0, s93, 132096
    s_nop 0
    buffer_load_dwordx4 v26, s[4:7], s94 offen lds
    v_smfmac_f32_16x16x64_bf16 v[96:99], v[92:95], v[84:91], v16
    v_exp_f32 v142, v142
    v_exp_f32 v143, v143
    v_exp_f32 v144, v144
    v_exp_f32 v145, v145
    v_exp_f32 v146, v146
    v_exp_f32 v147, v147
    v_cvt_pk_bf16_f32 v80, v140, v141
    v_cvt_pk_bf16_f32 v81, v142, v143
    v_cvt_pk_bf16_f32 v82, v144, v145
    v_cvt_pk_bf16_f32 v83, v146, v147
    s_setprio 2
    s_waitcnt lgkmcnt(4)
    v_mfma_f32_32x32x16_bf16 v[132:147], v[44:47], v[36:39], 0
    v_exp_f32 v116, v116
    v_exp_f32 v117, v117
    v_exp_f32 v118, v118
    v_mfma_f32_32x32x16_bf16 v[132:147], v[48:51], v[40:43], v[132:147]
    v_exp_f32 v119, v119
    v_exp_f32 v120, v120
    v_exp_f32 v121, v121
    ds_read_b128 v[44:47], v7 offset:40960
    ds_read_b128 v[48:51], v7 offset:41984
    v_mfma_f32_32x32x16_bf16 v[100:115], v[60:63], v[76:79], v[100:115]
    v_exp_f32 v122, v122
    v_exp_f32 v123, v123
    v_cvt_pk_bf16_f32 v84, v116, v117
    v_cvt_pk_bf16_f32 v85, v118, v119
    v_mfma_f32_32x32x16_bf16 v[100:115], v[64:67], v[80:83], v[100:115]
    v_exp_f32 v124, v124
    v_exp_f32 v125, v125
    v_cvt_pk_bf16_f32 v86, v120, v121
    v_cvt_pk_bf16_f32 v87, v122, v123
    ds_read_b128 v[60:63], v7 offset:34816
    ds_read_b128 v[64:67], v7 offset:35840
    s_add_u32 m0, s40, 32768
    s_add_u32 s93, s39, 163840
    buffer_load_dwordx4 v6, s[16:19], s93 offen offset:0 sc1 lds
    v_smfmac_f32_16x16x64_bf16 v[96:99], v[92:95], v[76:83], v16
    v_exp_f32 v126, v126
    v_exp_f32 v127, v127
    v_exp_f32 v128, v128
    v_exp_f32 v129, v129
    v_exp_f32 v130, v130
    v_exp_f32 v131, v131
    v_cvt_pk_bf16_f32 v88, v124, v125
    v_cvt_pk_bf16_f32 v89, v126, v127
    v_cvt_pk_bf16_f32 v90, v128, v129
    v_cvt_pk_bf16_f32 v91, v130, v131
    s_waitcnt lgkmcnt(4)
    v_mfma_f32_32x32x16_bf16 v[116:131], v[52:55], v[36:39], 0
    v_exp_f32 v132, v132
    v_exp_f32 v133, v133
    v_exp_f32 v134, v134
    v_mfma_f32_32x32x16_bf16 v[116:131], v[56:59], v[40:43], v[116:131]
    v_exp_f32 v135, v135
    v_exp_f32 v136, v136
    v_exp_f32 v137, v137
    ds_read_b128 v[52:55], v7 offset:45056
    ds_read_b128 v[56:59], v7 offset:46080
    v_mfma_f32_32x32x16_bf16 v[100:115], v[68:71], v[84:87], v[100:115]
    v_exp_f32 v138, v138
    v_exp_f32 v139, v139
    v_cvt_pk_bf16_f32 v76, v132, v133
    v_cvt_pk_bf16_f32 v77, v134, v135
    v_mfma_f32_32x32x16_bf16 v[100:115], v[72:75], v[88:91], v[100:115]
    v_exp_f32 v140, v140
    v_exp_f32 v141, v141
    v_cvt_pk_bf16_f32 v78, v136, v137
    v_cvt_pk_bf16_f32 v79, v138, v139
    ds_read_b128 v[68:71], v7 offset:38912
    ds_read_b128 v[72:75], v7 offset:39936
    s_add_u32 m0, s40, 32768
    s_add_u32 s93, s39, 163840
    buffer_load_dwordx4 v6, s[16:19], s93 offen offset:1024 sc1 lds
    v_smfmac_f32_16x16x64_bf16 v[96:99], v[92:95], v[84:91], v16
    v_exp_f32 v142, v142
    v_exp_f32 v143, v143
    v_exp_f32 v144, v144
    v_exp_f32 v145, v145
    v_exp_f32 v146, v146
    v_exp_f32 v147, v147
    v_cvt_pk_bf16_f32 v80, v140, v141
    v_cvt_pk_bf16_f32 v81, v142, v143
    v_cvt_pk_bf16_f32 v82, v144, v145
    v_cvt_pk_bf16_f32 v83, v146, v147
    s_setprio 1
    s_waitcnt lgkmcnt(4)
    v_mfma_f32_32x32x16_bf16 v[132:147], v[44:47], v[36:39], 0
    v_exp_f32 v116, v116
    v_exp_f32 v117, v117
    v_exp_f32 v118, v118
    v_mfma_f32_32x32x16_bf16 v[132:147], v[48:51], v[40:43], v[132:147]
    v_exp_f32 v119, v119
    v_exp_f32 v120, v120
    v_exp_f32 v121, v121
    ds_read_b128 v[44:47], v7 offset:49152
    ds_read_b128 v[48:51], v7 offset:50176
    v_mfma_f32_32x32x16_bf16 v[100:115], v[60:63], v[76:79], v[100:115]
    v_exp_f32 v122, v122
    v_exp_f32 v123, v123
    v_cvt_pk_bf16_f32 v84, v116, v117
    v_cvt_pk_bf16_f32 v85, v118, v119
    v_mfma_f32_32x32x16_bf16 v[100:115], v[64:67], v[80:83], v[100:115]
    v_exp_f32 v124, v124
    v_exp_f32 v125, v125
    v_cvt_pk_bf16_f32 v86, v120, v121
    v_cvt_pk_bf16_f32 v87, v122, v123
    ds_read_b128 v[60:63], v7 offset:43008
    ds_read_b128 v[64:67], v7 offset:44032
    s_add_u32 m0, s40, 32768
    s_add_u32 s93, s39, 163840
    buffer_load_dwordx4 v6, s[16:19], s93 offen offset:2048 sc1 lds
    v_smfmac_f32_16x16x64_bf16 v[96:99], v[92:95], v[76:83], v16
    v_exp_f32 v126, v126
    v_exp_f32 v127, v127
    v_exp_f32 v128, v128
    v_exp_f32 v129, v129
    v_exp_f32 v130, v130
    v_exp_f32 v131, v131
    v_cvt_pk_bf16_f32 v88, v124, v125
    v_cvt_pk_bf16_f32 v89, v126, v127
    v_cvt_pk_bf16_f32 v90, v128, v129
    v_cvt_pk_bf16_f32 v91, v130, v131
    s_waitcnt lgkmcnt(4)
    v_mfma_f32_32x32x16_bf16 v[116:131], v[52:55], v[36:39], 0
    v_exp_f32 v132, v132
    v_exp_f32 v133, v133
    v_exp_f32 v134, v134
    v_mfma_f32_32x32x16_bf16 v[116:131], v[56:59], v[40:43], v[116:131]
    v_exp_f32 v135, v135
    v_exp_f32 v136, v136
    v_exp_f32 v137, v137
    ds_read_b128 v[52:55], v7 offset:53248
    ds_read_b128 v[56:59], v7 offset:54272
    v_mfma_f32_32x32x16_bf16 v[100:115], v[68:71], v[84:87], v[100:115]
    v_exp_f32 v138, v138
    v_exp_f32 v139, v139
    v_cvt_pk_bf16_f32 v76, v132, v133
    v_cvt_pk_bf16_f32 v77, v134, v135
    v_mfma_f32_32x32x16_bf16 v[100:115], v[72:75], v[88:91], v[100:115]
    v_exp_f32 v140, v140
    v_exp_f32 v141, v141
    v_cvt_pk_bf16_f32 v78, v136, v137
    v_cvt_pk_bf16_f32 v79, v138, v139
    ds_read_b128 v[68:71], v7 offset:47104
    ds_read_b128 v[72:75], v7 offset:48128
    s_add_u32 m0, s40, 32768
    s_add_u32 s93, s39, 163840
    buffer_load_dwordx4 v6, s[16:19], s93 offen offset:3072 sc1 lds
    v_smfmac_f32_16x16x64_bf16 v[96:99], v[92:95], v[84:91], v16
    v_exp_f32 v142, v142
    v_exp_f32 v143, v143
    v_exp_f32 v144, v144
    v_exp_f32 v145, v145
    v_exp_f32 v146, v146
    v_exp_f32 v147, v147
    v_cvt_pk_bf16_f32 v80, v140, v141
    v_cvt_pk_bf16_f32 v81, v142, v143
    v_cvt_pk_bf16_f32 v82, v144, v145
    v_cvt_pk_bf16_f32 v83, v146, v147
    s_setprio 0
    s_waitcnt lgkmcnt(4)
    v_mfma_f32_32x32x16_bf16 v[132:147], v[44:47], v[36:39], 0
    v_exp_f32 v116, v116
    v_exp_f32 v117, v117
    v_exp_f32 v118, v118
    v_mfma_f32_32x32x16_bf16 v[132:147], v[48:51], v[40:43], v[132:147]
    v_exp_f32 v119, v119
    v_exp_f32 v120, v120
    v_exp_f32 v121, v121
    ds_read_b128 v[44:47], v7 offset:57344
    ds_read_b128 v[48:51], v7 offset:58368
    v_mfma_f32_32x32x16_bf16 v[100:115], v[60:63], v[76:79], v[100:115]
    v_exp_f32 v122, v122
    v_exp_f32 v123, v123
    v_cvt_pk_bf16_f32 v84, v116, v117
    v_cvt_pk_bf16_f32 v85, v118, v119
    v_mfma_f32_32x32x16_bf16 v[100:115], v[64:67], v[80:83], v[100:115]
    v_exp_f32 v124, v124
    v_exp_f32 v125, v125
    v_cvt_pk_bf16_f32 v86, v120, v121
    v_cvt_pk_bf16_f32 v87, v122, v123
    ds_read_b128 v[60:63], v7 offset:51200
    ds_read_b128 v[64:67], v7 offset:52224
    s_cmp_eq_u32 s3, 0
    s_cbranch_scc0 L_w2
    buffer_load_dwordx4 v[32:35], v29, s[16:19], 0 offen sc1
L_w2:
    v_smfmac_f32_16x16x64_bf16 v[96:99], v[92:95], v[76:83], v16
    v_exp_f32 v126, v126
    v_exp_f32 v127, v127
    v_exp_f32 v128, v128
    v_exp_f32 v129, v129
    v_exp_f32 v130, v130
    v_exp_f32 v131, v131
    v_cvt_pk_bf16_f32 v88, v124, v125
    v_cvt_pk_bf16_f32 v89, v126, v127
    v_cvt_pk_bf16_f32 v90, v128, v129
    v_cvt_pk_bf16_f32 v91, v130, v131
    s_waitcnt lgkmcnt(4)
    v_mfma_f32_32x32x16_bf16 v[116:131], v[52:55], v[36:39], 0
    v_exp_f32 v132, v132
    v_exp_f32 v133, v133
    v_exp_f32 v134, v134
    v_mfma_f32_32x32x16_bf16 v[116:131], v[56:59], v[40:43], v[116:131]
    v_exp_f32 v135, v135
    v_exp_f32 v136, v136
    v_exp_f32 v137, v137
    ds_read_b128 v[52:55], v7 offset:61440
    ds_read_b128 v[56:59], v7 offset:62464
    v_mfma_f32_32x32x16_bf16 v[100:115], v[68:71], v[84:87], v[100:115]
    v_exp_f32 v138, v138
    v_exp_f32 v139, v139
    v_cvt_pk_bf16_f32 v76, v132, v133
    v_cvt_pk_bf16_f32 v77, v134, v135
    v_mfma_f32_32x32x16_bf16 v[100:115], v[72:75], v[88:91], v[100:115]
    v_exp_f32 v140, v140
    v_exp_f32 v141, v141
    v_cvt_pk_bf16_f32 v78, v136, v137
    v_cvt_pk_bf16_f32 v79, v138, v139
    ds_read_b128 v[68:71], v7 offset:55296
    ds_read_b128 v[72:75], v7 offset:56320
    v_smfmac_f32_16x16x64_bf16 v[96:99], v[92:95], v[84:91], v16
    v_exp_f32 v142, v142
    v_exp_f32 v143, v143
    v_exp_f32 v144, v144
    v_exp_f32 v145, v145
    v_exp_f32 v146, v146
    v_exp_f32 v147, v147
    v_cvt_pk_bf16_f32 v80, v140, v141
    v_cvt_pk_bf16_f32 v81, v142, v143
    v_cvt_pk_bf16_f32 v82, v144, v145
    v_cvt_pk_bf16_f32 v83, v146, v147
    s_cmp_eq_u32 s3, 0
    s_cbranch_scc0 L_c3
    s_waitcnt vmcnt(0)
    v_and_b32 v32, v32, v33
    v_and_b32 v34, v34, v35
    v_and_b32 v32, v32, v34
    v_cmp_ne_u32 vcc, 0, v32
    s_nop 3
    s_cmp_eq_u64 vcc, exec
    s_cbranch_scc0 L_s3
L_c3:
    s_waitcnt vmcnt(6)
    s_barrier
    s_setprio 3
    s_waitcnt lgkmcnt(4)
    v_mfma_f32_32x32x16_bf16 v[132:147], v[44:47], v[36:39], 0
    v_exp_f32 v116, v116
    v_exp_f32 v117, v117
    v_exp_f32 v118, v118
    v_mfma_f32_32x32x16_bf16 v[132:147], v[48:51], v[40:43], v[132:147]
    v_exp_f32 v119, v119
    v_exp_f32 v120, v120
    v_exp_f32 v121, v121
    ds_read_b128 v[44:47], v6 offset:0
    ds_read_b128 v[48:51], v6 offset:1024
    v_mfma_f32_32x32x16_bf16 v[100:115], v[60:63], v[76:79], v[100:115]
    v_exp_f32 v122, v122
    v_exp_f32 v123, v123
    v_cvt_pk_bf16_f32 v84, v116, v117
    v_cvt_pk_bf16_f32 v85, v118, v119
    v_mfma_f32_32x32x16_bf16 v[100:115], v[64:67], v[80:83], v[100:115]
    v_exp_f32 v124, v124
    v_exp_f32 v125, v125
    v_cvt_pk_bf16_f32 v86, v120, v121
    v_cvt_pk_bf16_f32 v87, v122, v123
    ds_read_b128 v[60:63], v7 offset:59392
    ds_read_b128 v[64:67], v7 offset:60416
    s_add_u32 m0, s40, 65536
    s_add_u32 s93, s51, 0
    buffer_load_dwordx4 v6, s[16:19], s93 offen offset:0 sc1 lds
    v_smfmac_f32_16x16x64_bf16 v[96:99], v[92:95], v[76:83], v16
    v_exp_f32 v126, v126
    v_exp_f32 v127, v127
    v_exp_f32 v128, v128
    v_exp_f32 v129, v129
    v_exp_f32 v130, v130
    v_exp_f32 v131, v131
    v_cvt_pk_bf16_f32 v88, v124, v125
    v_cvt_pk_bf16_f32 v89, v126, v127
    v_cvt_pk_bf16_f32 v90, v128, v129
    v_cvt_pk_bf16_f32 v91, v130, v131
    s_waitcnt lgkmcnt(4)
    v_mfma_f32_32x32x16_bf16 v[116:131], v[52:55], v[36:39], 0
    v_exp_f32 v132, v132
    v_exp_f32 v133, v133
    v_exp_f32 v134, v134
    v_mfma_f32_32x32x16_bf16 v[116:131], v[56:59], v[40:43], v[116:131]
    v_exp_f32 v135, v135
    v_exp_f32 v136, v136
    v_exp_f32 v137, v137
    ds_read_b128 v[52:55], v6 offset:4096
    ds_read_b128 v[56:59], v6 offset:5120
    v_mfma_f32_32x32x16_bf16 v[100:115], v[68:71], v[84:87], v[100:115]
    v_exp_f32 v138, v138
    v_exp_f32 v139, v139
    v_cvt_pk_bf16_f32 v76, v132, v133
    v_cvt_pk_bf16_f32 v77, v134, v135
    v_mfma_f32_32x32x16_bf16 v[100:115], v[72:75], v[88:91], v[100:115]
    v_exp_f32 v140, v140
    v_exp_f32 v141, v141
    v_cvt_pk_bf16_f32 v78, v136, v137
    v_cvt_pk_bf16_f32 v79, v138, v139
    ds_read_b128 v[68:71], v7 offset:63488
    ds_read_b128 v[72:75], v7 offset:64512
    s_add_u32 m0, s40, 65536
    s_add_u32 s93, s51, 0
    buffer_load_dwordx4 v6, s[16:19], s93 offen offset:1024 sc1 lds
    v_smfmac_f32_16x16x64_bf16 v[96:99], v[92:95], v[84:91], v16
    v_exp_f32 v142, v142
    v_exp_f32 v143, v143
    v_exp_f32 v144, v144
    v_exp_f32 v145, v145
    v_exp_f32 v146, v146
    v_exp_f32 v147, v147
    v_cvt_pk_bf16_f32 v80, v140, v141
    v_cvt_pk_bf16_f32 v81, v142, v143
    v_cvt_pk_bf16_f32 v82, v144, v145
    v_cvt_pk_bf16_f32 v83, v146, v147
    s_setprio 2
    s_waitcnt lgkmcnt(4)
    v_mfma_f32_32x32x16_bf16 v[132:147], v[44:47], v[36:39], 0
    v_exp_f32 v116, v116
    v_exp_f32 v117, v117
    v_exp_f32 v118, v118
    v_mfma_f32_32x32x16_bf16 v[132:147], v[48:51], v[40:43], v[132:147]
    v_exp_f32 v119, v119
    v_exp_f32 v120, v120
    v_exp_f32 v121, v121
    ds_read_b128 v[44:47], v6 offset:8192
    ds_read_b128 v[48:51], v6 offset:9216
    v_mfma_f32_32x32x16_bf16 v[100:115], v[60:63], v[76:79], v[100:115]
    v_exp_f32 v122, v122
    v_exp_f32 v123, v123
    v_cvt_pk_bf16_f32 v84, v116, v117
    v_cvt_pk_bf16_f32 v85, v118, v119
    v_mfma_f32_32x32x16_bf16 v[100:115], v[64:67], v[80:83], v[100:115]
    v_exp_f32 v124, v124
    v_exp_f32 v125, v125
    v_cvt_pk_bf16_f32 v86, v120, v121
    v_cvt_pk_bf16_f32 v87, v122, v123
    ds_read_b128 v[60:63], v6 offset:2048
    ds_read_b128 v[64:67], v6 offset:3072
    s_add_u32 m0, s40, 65536
    s_add_u32 s93, s51, 0
    buffer_load_dwordx4 v6, s[16:19], s93 offen offset:2048 sc1 lds
    v_smfmac_f32_16x16x64_bf16 v[96:99], v[92:95], v[76:83], v16
    v_exp_f32 v126, v126
    v_exp_f32 v127, v127
    v_exp_f32 v128, v128
    v_exp_f32 v129, v129
    v_exp_f32 v130, v130
    v_exp_f32 v131, v131
    v_cvt_pk_bf16_f32 v88, v124, v125
    v_cvt_pk_bf16_f32 v89, v126, v127
    v_cvt_pk_bf16_f32 v90, v128, v129
    v_cvt_pk_bf16_f32 v91, v130, v131
    s_waitcnt lgkmcnt(4)
    v_mfma_f32_32x32x16_bf16 v[116:131], v[52:55], v[36:39], 0
    v_exp_f32 v132, v132
    v_exp_f32 v133, v133
    v_exp_f32 v134, v134
    v_mfma_f32_32x32x16_bf16 v[116:131], v[56:59], v[40:43], v[116:131]
    v_exp_f32 v135, v135
    v_exp_f32 v136, v136
    v_exp_f32 v137, v137
    ds_read_b128 v[52:55], v6 offset:12288
    ds_read_b128 v[56:59], v6 offset:13312
    v_mfma_f32_32x32x16_bf16 v[100:115], v[68:71], v[84:87], v[100:115]
    v_exp_f32 v138, v138
    v_exp_f32 v139, v139
    v_cvt_pk_bf16_f32 v76, v132, v133
    v_cvt_pk_bf16_f32 v77, v134, v135
    v_mfma_f32_32x32x16_bf16 v[100:115], v[72:75], v[88:91], v[100:115]
    v_exp_f32 v140, v140
    v_exp_f32 v141, v141
    v_cvt_pk_bf16_f32 v78, v136, v137
    v_cvt_pk_bf16_f32 v79, v138, v139
    ds_read_b128 v[68:71], v6 offset:6144
    ds_read_b128 v[72:75], v6 offset:7168
    s_add_u32 m0, s40, 65536
    s_add_u32 s93, s51, 0
    buffer_load_dwordx4 v6, s[16:19], s93 offen offset:3072 sc1 lds
    v_smfmac_f32_16x16x64_bf16 v[96:99], v[92:95], v[84:91], v16
    v_exp_f32 v142, v142
    v_exp_f32 v143, v143
    v_exp_f32 v144, v144
    v_exp_f32 v145, v145
    v_exp_f32 v146, v146
    v_exp_f32 v147, v147
    v_cvt_pk_bf16_f32 v80, v140, v141
    v_cvt_pk_bf16_f32 v81, v142, v143
    v_cvt_pk_bf16_f32 v82, v144, v145
    v_cvt_pk_bf16_f32 v83, v146, v147
    s_setprio 1
    s_waitcnt lgkmcnt(4)
    v_mfma_f32_32x32x16_bf16 v[132:147], v[44:47], v[36:39], 0
    v_exp_f32 v116, v116
    v_exp_f32 v117, v117
    v_exp_f32 v118, v118
    v_mfma_f32_32x32x16_bf16 v[132:147], v[48:51], v[40:43], v[132:147]
    v_exp_f32 v119, v119
    v_exp_f32 v120, v120
    v_exp_f32 v121, v121
    ds_read_b128 v[44:47], v6 offset:16384
    ds_read_b128 v[48:51], v6 offset:17408
    v_mfma_f32_32x32x16_bf16 v[100:115], v[60:63], v[76:79], v[100:115]
    v_exp_f32 v122, v122
    v_exp_f32 v123, v123
    v_cvt_pk_bf16_f32 v84, v116, v117
    v_cvt_pk_bf16_f32 v85, v118, v119
    v_mfma_f32_32x32x16_bf16 v[100:115], v[64:67], v[80:83], v[100:115]
    v_exp_f32 v124, v124
    v_exp_f32 v125, v125
    v_cvt_pk_bf16_f32 v86, v120, v121
    v_cvt_pk_bf16_f32 v87, v122, v123
    ds_read_b128 v[60:63], v6 offset:10240
    ds_read_b128 v[64:67], v6 offset:11264
    v_smfmac_f32_16x16x64_bf16 v[96:99], v[92:95], v[76:83], v16
    v_exp_f32 v126, v126
    v_exp_f32 v127, v127
    v_exp_f32 v128, v128
    v_exp_f32 v129, v129
    v_exp_f32 v130, v130
    v_exp_f32 v131, v131
    v_cvt_pk_bf16_f32 v88, v124, v125
    v_cvt_pk_bf16_f32 v89, v126, v127
    v_cvt_pk_bf16_f32 v90, v128, v129
    v_cvt_pk_bf16_f32 v91, v130, v131
    s_waitcnt vmcnt(8)
    ds_read_b64_tr_b16 v[208:209], v27
    ds_read_b64_tr_b16 v[210:211], v27 offset:512
    ds_read_b64_tr_b16 v[212:213], v27 offset:32
    ds_read_b64_tr_b16 v[214:215], v27 offset:544
    s_waitcnt lgkmcnt(0)
    buffer_store_dwordx4 v[208:211], v6, s[16:19], s30 offen sc1
    buffer_store_dwordx4 v[212:215], v6, s[16:19], s30 offen offset:1024 sc1
    s_waitcnt lgkmcnt(4)
    v_mfma_f32_32x32x16_bf16 v[116:131], v[52:55], v[36:39], 0
    v_exp_f32 v132, v132
    v_exp_f32 v133, v133
    v_exp_f32 v134, v134
    v_mfma_f32_32x32x16_bf16 v[116:131], v[56:59], v[40:43], v[116:131]
    v_exp_f32 v135, v135
    v_exp_f32 v136, v136
    v_exp_f32 v137, v137
    ds_read_b128 v[52:55], v6 offset:20480
    ds_read_b128 v[56:59], v6 offset:21504
    v_mfma_f32_32x32x16_bf16 v[100:115], v[68:71], v[84:87], v[100:115]
    v_exp_f32 v138, v138
    v_exp_f32 v139, v139
    v_cvt_pk_bf16_f32 v76, v132, v133
    v_cvt_pk_bf16_f32 v77, v134, v135
    v_mfma_f32_32x32x16_bf16 v[100:115], v[72:75], v[88:91], v[100:115]
    v_exp_f32 v140, v140
    v_exp_f32 v141, v141
    v_cvt_pk_bf16_f32 v78, v136, v137
    v_cvt_pk_bf16_f32 v79, v138, v139
    ds_read_b128 v[68:71], v6 offset:14336
    ds_read_b128 v[72:75], v6 offset:15360
    v_smfmac_f32_16x16x64_bf16 v[96:99], v[92:95], v[84:91], v16
    v_exp_f32 v142, v142
    v_exp_f32 v143, v143
    v_exp_f32 v144, v144
    v_exp_f32 v145, v145
    v_exp_f32 v146, v146
    v_exp_f32 v147, v147
    v_cvt_pk_bf16_f32 v80, v140, v141
    v_cvt_pk_bf16_f32 v81, v142, v143
    v_cvt_pk_bf16_f32 v82, v144, v145
    v_cvt_pk_bf16_f32 v83, v146, v147
    s_setprio 0
    s_waitcnt lgkmcnt(4)
    v_mfma_f32_32x32x16_bf16 v[132:147], v[44:47], v[36:39], 0
    v_exp_f32 v116, v116
    v_exp_f32 v117, v117
    v_exp_f32 v118, v118
    v_mfma_f32_32x32x16_bf16 v[132:147], v[48:51], v[40:43], v[132:147]
    v_exp_f32 v119, v119
    v_exp_f32 v120, v120
    v_exp_f32 v121, v121
    ds_read_b128 v[44:47], v6 offset:24576
    ds_read_b128 v[48:51], v6 offset:25600
    v_mfma_f32_32x32x16_bf16 v[100:115], v[60:63], v[76:79], v[100:115]
    v_exp_f32 v122, v122
    v_exp_f32 v123, v123
    v_cvt_pk_bf16_f32 v84, v116, v117
    v_cvt_pk_bf16_f32 v85, v118, v119
    v_mfma_f32_32x32x16_bf16 v[100:115], v[64:67], v[80:83], v[100:115]
    v_exp_f32 v124, v124
    v_exp_f32 v125, v125
    v_cvt_pk_bf16_f32 v86, v120, v121
    v_cvt_pk_bf16_f32 v87, v122, v123
    ds_read_b128 v[60:63], v6 offset:18432
    ds_read_b128 v[64:67], v6 offset:19456
    v_smfmac_f32_16x16x64_bf16 v[96:99], v[92:95], v[76:83], v16
    v_exp_f32 v126, v126
    v_exp_f32 v127, v127
    v_exp_f32 v128, v128
    v_exp_f32 v129, v129
    v_exp_f32 v130, v130
    v_exp_f32 v131, v131
    v_cvt_pk_bf16_f32 v88, v124, v125
    v_cvt_pk_bf16_f32 v89, v126, v127
    v_cvt_pk_bf16_f32 v90, v128, v129
    v_cvt_pk_bf16_f32 v91, v130, v131
    s_waitcnt lgkmcnt(4)
    v_mfma_f32_32x32x16_bf16 v[116:131], v[52:55], v[36:39], 0
    v_exp_f32 v132, v132
    v_exp_f32 v133, v133
    v_exp_f32 v134, v134
    v_mfma_f32_32x32x16_bf16 v[116:131], v[56:59], v[40:43], v[116:131]
    v_exp_f32 v135, v135
    v_exp_f32 v136, v136
    v_exp_f32 v137, v137
    ds_read_b128 v[52:55], v6 offset:28672
    ds_read_b128 v[56:59], v6 offset:29696
    v_mfma_f32_32x32x16_bf16 v[100:115], v[68:71], v[84:87], v[100:115]
    v_exp_f32 v138, v138
    v_exp_f32 v139, v139
    v_cvt_pk_bf16_f32 v76, v132, v133
    v_cvt_pk_bf16_f32 v77, v134, v135
    v_mfma_f32_32x32x16_bf16 v[100:115], v[72:75], v[88:91], v[100:115]
    v_exp_f32 v140, v140
    v_exp_f32 v141, v141
    v_cvt_pk_bf16_f32 v78, v136, v137
    v_cvt_pk_bf16_f32 v79, v138, v139
    ds_read_b128 v[68:71], v6 offset:22528
    ds_read_b128 v[72:75], v6 offset:23552
    v_smfmac_f32_16x16x64_bf16 v[96:99], v[92:95], v[84:91], v16
    v_exp_f32 v142, v142
    v_exp_f32 v143, v143
    v_exp_f32 v144, v144
    v_exp_f32 v145, v145
    v_exp_f32 v146, v146
    v_exp_f32 v147, v147
    v_cvt_pk_bf16_f32 v80, v140, v141
    v_cvt_pk_bf16_f32 v81, v142, v143
    v_cvt_pk_bf16_f32 v82, v144, v145
    v_cvt_pk_bf16_f32 v83, v146, v147
    s_waitcnt vmcnt(6)
    s_barrier
    s_setprio 3
    s_waitcnt lgkmcnt(4)
    v_mfma_f32_32x32x16_bf16 v[132:147], v[44:47], v[36:39], 0
    v_exp_f32 v116, v116
    v_exp_f32 v117, v117
    v_exp_f32 v118, v118
    v_mfma_f32_32x32x16_bf16 v[132:147], v[48:51], v[40:43], v[132:147]
    v_exp_f32 v119, v119
    v_exp_f32 v120, v120
    v_exp_f32 v121, v121
    ds_read_b128 v[44:47], v6 offset:32768
    ds_read_b128 v[48:51], v6 offset:33792
    v_mfma_f32_32x32x16_bf16 v[100:115], v[60:63], v[76:79], v[100:115]
    v_exp_f32 v122, v122
    v_exp_f32 v123, v123
    v_cvt_pk_bf16_f32 v84, v116, v117
    v_cvt_pk_bf16_f32 v85, v118, v119
    v_mfma_f32_32x32x16_bf16 v[100:115], v[64:67], v[80:83], v[100:115]
    v_exp_f32 v124, v124
    v_exp_f32 v125, v125
    v_cvt_pk_bf16_f32 v86, v120, v121
    v_cvt_pk_bf16_f32 v87, v122, v123
    ds_read_b128 v[60:63], v6 offset:26624
    ds_read_b128 v[64:67], v6 offset:27648
    s_add_u32 m0, s40, 98304
    s_add_u32 s93, s52, 0
    buffer_load_dwordx4 v6, s[16:19], s93 offen offset:0 sc1 lds
    v_smfmac_f32_16x16x64_bf16 v[96:99], v[92:95], v[76:83], v16
    v_exp_f32 v126, v126
    v_exp_f32 v127, v127
    v_exp_f32 v128, v128
    v_exp_f32 v129, v129
    v_exp_f32 v130, v130
    v_exp_f32 v131, v131
    v_cvt_pk_bf16_f32 v88, v124, v125
    v_cvt_pk_bf16_f32 v89, v126, v127
    v_cvt_pk_bf16_f32 v90, v128, v129
    v_cvt_pk_bf16_f32 v91, v130, v131
    s_waitcnt lgkmcnt(4)
    v_mfma_f32_32x32x16_bf16 v[116:131], v[52:55], v[36:39], 0
    v_exp_f32 v132, v132
    v_exp_f32 v133, v133
    v_exp_f32 v134, v134
    v_mfma_f32_32x32x16_bf16 v[116:131], v[56:59], v[40:43], v[116:131]
    v_exp_f32 v135, v135
    v_exp_f32 v136, v136
    v_exp_f32 v137, v137
    ds_read_b128 v[52:55], v6 offset:36864
    ds_read_b128 v[56:59], v6 offset:37888
    v_mfma_f32_32x32x16_bf16 v[100:115], v[68:71], v[84:87], v[100:115]
    v_exp_f32 v138, v138
    v_exp_f32 v139, v139
    v_cvt_pk_bf16_f32 v76, v132, v133
    v_cvt_pk_bf16_f32 v77, v134, v135
    v_mfma_f32_32x32x16_bf16 v[100:115], v[72:75], v[88:91], v[100:115]
    v_exp_f32 v140, v140
    v_exp_f32 v141, v141
    v_cvt_pk_bf16_f32 v78, v136, v137
    v_cvt_pk_bf16_f32 v79, v138, v139
    ds_read_b128 v[68:71], v6 offset:30720
    ds_read_b128 v[72:75], v6 offset:31744
    s_add_u32 m0, s40, 98304
    s_add_u32 s93, s52, 0
    buffer_load_dwordx4 v6, s[16:19], s93 offen offset:1024 sc1 lds
    v_smfmac_f32_16x16x64_bf16 v[96:99], v[92:95], v[84:91], v16
    v_exp_f32 v142, v142
    v_exp_f32 v143, v143
    v_exp_f32 v144, v144
    v_exp_f32 v145, v145
    v_exp_f32 v146, v146
    v_exp_f32 v147, v147
    v_cvt_pk_bf16_f32 v80, v140, v141
    v_cvt_pk_bf16_f32 v81, v142, v143
    v_cvt_pk_bf16_f32 v82, v144, v145
    v_cvt_pk_bf16_f32 v83, v146, v147
    s_setprio 2
    s_waitcnt lgkmcnt(4)
    v_mfma_f32_32x32x16_bf16 v[132:147], v[44:47], v[36:39], 0
    v_exp_f32 v116, v116
    v_exp_f32 v117, v117
    v_exp_f32 v118, v118
    v_mfma_f32_32x32x16_bf16 v[132:147], v[48:51], v[40:43], v[132:147]
    v_exp_f32 v119, v119
    v_exp_f32 v120, v120
    v_exp_f32 v121, v121
    ds_read_b128 v[44:47], v6 offset:40960
    ds_read_b128 v[48:51], v6 offset:41984
    v_mfma_f32_32x32x16_bf16 v[100:115], v[60:63], v[76:79], v[100:115]
    v_exp_f32 v122, v122
    v_exp_f32 v123, v123
    v_cvt_pk_bf16_f32 v84, v116, v117
    v_cvt_pk_bf16_f32 v85, v118, v119
    v_mfma_f32_32x32x16_bf16 v[100:115], v[64:67], v[80:83], v[100:115]
    v_exp_f32 v124, v124
    v_exp_f32 v125, v125
    v_cvt_pk_bf16_f32 v86, v120, v121
    v_cvt_pk_bf16_f32 v87, v122, v123
    ds_read_b128 v[60:63], v6 offset:34816
    ds_read_b128 v[64:67], v6 offset:35840
    s_add_u32 m0, s40, 98304
    s_add_u32 s93, s52, 0
    buffer_load_dwordx4 v6, s[16:19], s93 offen offset:2048 sc1 lds
    v_smfmac_f32_16x16x64_bf16 v[96:99], v[92:95], v[76:83], v16
    v_exp_f32 v126, v126
    v_exp_f32 v127, v127
    v_exp_f32 v128, v128
    v_exp_f32 v129, v129
    v_exp_f32 v130, v130
    v_exp_f32 v131, v131
    v_cvt_pk_bf16_f32 v88, v124, v125
    v_cvt_pk_bf16_f32 v89, v126, v127
    v_cvt_pk_bf16_f32 v90, v128, v129
    v_cvt_pk_bf16_f32 v91, v130, v131
    s_waitcnt lgkmcnt(4)
    v_mfma_f32_32x32x16_bf16 v[116:131], v[52:55], v[36:39], 0
    v_exp_f32 v132, v132
    v_exp_f32 v133, v133
    v_exp_f32 v134, v134
    v_mfma_f32_32x32x16_bf16 v[116:131], v[56:59], v[40:43], v[116:131]
    v_exp_f32 v135, v135
    v_exp_f32 v136, v136
    v_exp_f32 v137, v137
    ds_read_b128 v[52:55], v6 offset:45056
    ds_read_b128 v[56:59], v6 offset:46080
    v_mfma_f32_32x32x16_bf16 v[100:115], v[68:71], v[84:87], v[100:115]
    v_exp_f32 v138, v138
    v_exp_f32 v139, v139
    v_cvt_pk_bf16_f32 v76, v132, v133
    v_cvt_pk_bf16_f32 v77, v134, v135
    v_mfma_f32_32x32x16_bf16 v[100:115], v[72:75], v[88:91], v[100:115]
    v_exp_f32 v140, v140
    v_exp_f32 v141, v141
    v_cvt_pk_bf16_f32 v78, v136, v137
    v_cvt_pk_bf16_f32 v79, v138, v139
    ds_read_b128 v[68:71], v6 offset:38912
    ds_read_b128 v[72:75], v6 offset:39936
    s_add_u32 m0, s40, 98304
    s_add_u32 s93, s52, 0
    buffer_load_dwordx4 v6, s[16:19], s93 offen offset:3072 sc1 lds
    v_smfmac_f32_16x16x64_bf16 v[96:99], v[92:95], v[84:91], v16
    v_exp_f32 v142, v142
    v_exp_f32 v143, v143
    v_exp_f32 v144, v144
    v_exp_f32 v145, v145
    v_exp_f32 v146, v146
    v_exp_f32 v147, v147
    v_cvt_pk_bf16_f32 v80, v140, v141
    v_cvt_pk_bf16_f32 v81, v142, v143
    v_cvt_pk_bf16_f32 v82, v144, v145
    v_cvt_pk_bf16_f32 v83, v146, v147
    s_waitcnt lgkmcnt(4)
    v_mfma_f32_32x32x16_bf16 v[132:147], v[44:47], v[36:39], 0
    v_exp_f32 v116, v116
    v_exp_f32 v117, v117
    v_exp_f32 v118, v118
    v_mfma_f32_32x32x16_bf16 v[132:147], v[48:51], v[40:43], v[132:147]
    v_exp_f32 v119, v119
    v_exp_f32 v120, v120
    v_exp_f32 v121, v121
    ds_read_b128 v[44:47], v6 offset:49152
    ds_read_b128 v[48:51], v6 offset:50176
    v_mfma_f32_32x32x16_bf16 v[100:115], v[60:63], v[76:79], v[100:115]
    v_exp_f32 v122, v122
    v_exp_f32 v123, v123
    v_cvt_pk_bf16_f32 v84, v116, v117
    v_cvt_pk_bf16_f32 v85, v118, v119
    v_mfma_f32_32x32x16_bf16 v[100:115], v[64:67], v[80:83], v[100:115]
    v_exp_f32 v124, v124
    v_exp_f32 v125, v125
    v_cvt_pk_bf16_f32 v86, v120, v121
    v_cvt_pk_bf16_f32 v87, v122, v123
    ds_read_b128 v[60:63], v6 offset:43008
    ds_read_b128 v[64:67], v6 offset:44032
    s_add_u32 s93, s44, 0
    buffer_load_dwordx4 v[200:203], v6, s[16:19], s93 offen sc1
    v_smfmac_f32_16x16x64_bf16 v[96:99], v[92:95], v[76:83], v16
    v_exp_f32 v126, v126
    v_exp_f32 v127, v127
    v_exp_f32 v128, v128
    v_exp_f32 v129, v129
    v_exp_f32 v130, v130
    v_exp_f32 v131, v131
    v_cvt_pk_bf16_f32 v88, v124, v125
    v_cvt_pk_bf16_f32 v89, v126, v127
    v_cvt_pk_bf16_f32 v90, v128, v129
    v_cvt_pk_bf16_f32 v91, v130, v131
    s_setprio 1
    s_waitcnt lgkmcnt(4)
    v_mfma_f32_32x32x16_bf16 v[116:131], v[52:55], v[36:39], 0
    v_exp_f32 v132, v132
    v_exp_f32 v133, v133
    v_exp_f32 v134, v134
    v_mfma_f32_32x32x16_bf16 v[116:131], v[56:59], v[40:43], v[116:131]
    v_exp_f32 v135, v135
    v_exp_f32 v136, v136
    v_exp_f32 v137, v137
    ds_read_b128 v[52:55], v6 offset:53248
    ds_read_b128 v[56:59], v6 offset:54272
    v_mfma_f32_32x32x16_bf16 v[100:115], v[68:71], v[84:87], v[100:115]
    v_exp_f32 v138, v138
    v_exp_f32 v139, v139
    v_cvt_pk_bf16_f32 v76, v132, v133
    v_cvt_pk_bf16_f32 v77, v134, v135
    v_mfma_f32_32x32x16_bf16 v[100:115], v[72:75], v[88:91], v[100:115]
    v_exp_f32 v140, v140
    v_exp_f32 v141, v141
    v_cvt_pk_bf16_f32 v78, v136, v137
    v_cvt_pk_bf16_f32 v79, v138, v139
    ds_read_b128 v[68:71], v6 offset:47104
    ds_read_b128 v[72:75], v6 offset:48128
    s_add_u32 s93, s44, 0
    buffer_load_dwordx4 v[204:207], v6, s[16:19], s93 offen offset:1024 sc1
    v_smfmac_f32_16x16x64_bf16 v[96:99], v[92:95], v[84:91], v16
    v_exp_f32 v142, v142
    v_exp_f32 v143, v143
    v_exp_f32 v144, v144
    v_exp_f32 v145, v145
    v_exp_f32 v146, v146
    v_exp_f32 v147, v147
    v_cvt_pk_bf16_f32 v80, v140, v141
    v_cvt_pk_bf16_f32 v81, v142, v143
    v_cvt_pk_bf16_f32 v82, v144, v145
    v_cvt_pk_bf16_f32 v83, v146, v147
    s_waitcnt lgkmcnt(4)
    v_mfma_f32_32x32x16_bf16 v[132:147], v[44:47], v[36:39], 0
    v_exp_f32 v116, v116
    v_exp_f32 v117, v117
    v_exp_f32 v118, v118
    v_mfma_f32_32x32x16_bf16 v[132:147], v[48:51], v[40:43], v[132:147]
    v_exp_f32 v119, v119
    v_exp_f32 v120, v120
    v_exp_f32 v121, v121
    ds_read_b128 v[44:47], v6 offset:57344
    ds_read_b128 v[48:51], v6 offset:58368
    v_mfma_f32_32x32x16_bf16 v[100:115], v[60:63], v[76:79], v[100:115]
    v_exp_f32 v122, v122
    v_exp_f32 v123, v123
    v_cvt_pk_bf16_f32 v84, v116, v117
    v_cvt_pk_bf16_f32 v85, v118, v119
    v_mfma_f32_32x32x16_bf16 v[100:115], v[64:67], v[80:83], v[100:115]
    v_exp_f32 v124, v124
    v_exp_f32 v125, v125
    v_cvt_pk_bf16_f32 v86, v120, v121
    v_cvt_pk_bf16_f32 v87, v122, v123
    ds_read_b128 v[60:63], v6 offset:51200
    ds_read_b128 v[64:67], v6 offset:52224
    s_lshl_b32 s93, s41, 7
    s_add_u32 s93, s93, 33619968
    s_add_u32 s94, s93, 8192
    buffer_load_dword v13, v12, s[16:19], s93 offen sc1
    buffer_load_dword v14, v12, s[16:19], s94 offen sc1
    s_add_u32 s44, s44, 25165824
    s_add_u32 s45, s44, 4194304
    v_smfmac_f32_16x16x64_bf16 v[96:99], v[92:95], v[76:83], v16
    v_exp_f32 v126, v126
    v_exp_f32 v127, v127
    v_exp_f32 v128, v128
    v_exp_f32 v129, v129
    v_exp_f32 v130, v130
    v_exp_f32 v131, v131
    v_cvt_pk_bf16_f32 v88, v124, v125
    v_cvt_pk_bf16_f32 v89, v126, v127
    v_cvt_pk_bf16_f32 v90, v128, v129
    v_cvt_pk_bf16_f32 v91, v130, v131
    s_waitcnt lgkmcnt(4)
    v_mfma_f32_32x32x16_bf16 v[116:131], v[52:55], v[36:39], 0
    v_exp_f32 v132, v132
    v_exp_f32 v133, v133
    v_exp_f32 v134, v134
    v_mfma_f32_32x32x16_bf16 v[116:131], v[56:59], v[40:43], v[116:131]
    v_exp_f32 v135, v135
    v_exp_f32 v136, v136
    v_exp_f32 v137, v137
    ds_read_b128 v[52:55], v6 offset:61440
    ds_read_b128 v[56:59], v6 offset:62464
    v_mfma_f32_32x32x16_bf16 v[100:115], v[68:71], v[84:87], v[100:115]
    v_exp_f32 v138, v138
    v_exp_f32 v139, v139
    v_cvt_pk_bf16_f32 v76, v132, v133
    v_cvt_pk_bf16_f32 v77, v134, v135
    v_mfma_f32_32x32x16_bf16 v[100:115], v[72:75], v[88:91], v[100:115]
    v_exp_f32 v140, v140
    v_exp_f32 v141, v141
    v_cvt_pk_bf16_f32 v78, v136, v137
    v_cvt_pk_bf16_f32 v79, v138, v139
    ds_read_b128 v[68:71], v6 offset:55296
    ds_read_b128 v[72:75], v6 offset:56320
    v_smfmac_f32_16x16x64_bf16 v[96:99], v[92:95], v[84:91], v16
    v_exp_f32 v142, v142
    v_exp_f32 v143, v143
    v_exp_f32 v144, v144
    v_exp_f32 v145, v145
    v_exp_f32 v146, v146
    v_exp_f32 v147, v147
    v_cvt_pk_bf16_f32 v80, v140, v141
    v_cvt_pk_bf16_f32 v81, v142, v143
    v_cvt_pk_bf16_f32 v82, v144, v145
    v_cvt_pk_bf16_f32 v83, v146, v147
    s_setprio 0
    s_waitcnt lgkmcnt(4)
    v_mfma_f32_32x32x16_bf16 v[132:147], v[44:47], v[36:39], 0
    v_exp_f32 v116, v116
    v_exp_f32 v117, v117
    v_exp_f32 v118, v118
    v_mfma_f32_32x32x16_bf16 v[132:147], v[48:51], v[40:43], v[132:147]
    v_exp_f32 v119, v119
    v_exp_f32 v120, v120
    v_exp_f32 v121, v121
    v_mfma_f32_32x32x16_bf16 v[100:115], v[60:63], v[76:79], v[100:115]
    v_exp_f32 v122, v122
    v_exp_f32 v123, v123
    v_cvt_pk_bf16_f32 v84, v116, v117
    v_cvt_pk_bf16_f32 v85, v118, v119
    v_mfma_f32_32x32x16_bf16 v[100:115], v[64:67], v[80:83], v[100:115]
    v_exp_f32 v124, v124
    v_exp_f32 v125, v125
    v_cvt_pk_bf16_f32 v86, v120, v121
    v_cvt_pk_bf16_f32 v87, v122, v123
    ds_read_b128 v[60:63], v6 offset:59392
    ds_read_b128 v[64:67], v6 offset:60416
    v_smfmac_f32_16x16x64_bf16 v[96:99], v[92:95], v[76:83], v16
    v_exp_f32 v126, v126
    v_exp_f32 v127, v127
    v_exp_f32 v128, v128
    v_exp_f32 v129, v129
    v_exp_f32 v130, v130
    v_exp_f32 v131, v131
    v_cvt_pk_bf16_f32 v88, v124, v125
    v_cvt_pk_bf16_f32 v89, v126, v127
    v_cvt_pk_bf16_f32 v90, v128, v129
    v_cvt_pk_bf16_f32 v91, v130, v131
    s_waitcnt lgkmcnt(2)
    v_mfma_f32_32x32x16_bf16 v[116:131], v[52:55], v[36:39], 0
    v_exp_f32 v132, v132
    v_exp_f32 v133, v133
    v_exp_f32 v134, v134
    v_mfma_f32_32x32x16_bf16 v[116:131], v[56:59], v[40:43], v[116:131]
    v_exp_f32 v135, v135
    v_exp_f32 v136, v136
    v_exp_f32 v137, v137
    v_mfma_f32_32x32x16_bf16 v[100:115], v[68:71], v[84:87], v[100:115]
    v_exp_f32 v138, v138
    v_exp_f32 v139, v139
    v_cvt_pk_bf16_f32 v76, v132, v133
    v_cvt_pk_bf16_f32 v77, v134, v135
    v_mfma_f32_32x32x16_bf16 v[100:115], v[72:75], v[88:91], v[100:115]
    v_exp_f32 v140, v140
    v_exp_f32 v141, v141
    v_cvt_pk_bf16_f32 v78, v136, v137
    v_cvt_pk_bf16_f32 v79, v138, v139
    ds_read_b128 v[68:71], v6 offset:63488
    ds_read_b128 v[72:75], v6 offset:64512
    v_smfmac_f32_16x16x64_bf16 v[96:99], v[92:95], v[84:91], v16
    v_exp_f32 v142, v142
    v_exp_f32 v143, v143
    v_exp_f32 v144, v144
    v_exp_f32 v145, v145
    v_exp_f32 v146, v146
    v_exp_f32 v147, v147
    v_cvt_pk_bf16_f32 v80, v140, v141
    v_cvt_pk_bf16_f32 v81, v142, v143
    v_cvt_pk_bf16_f32 v82, v144, v145
    v_cvt_pk_bf16_f32 v83, v146, v147
    s_waitcnt lgkmcnt(2)
    v_exp_f32 v116, v116
    v_exp_f32 v117, v117
    v_exp_f32 v118, v118
    v_exp_f32 v119, v119
    v_exp_f32 v120, v120
    v_exp_f32 v121, v121
    v_mfma_f32_32x32x16_bf16 v[100:115], v[60:63], v[76:79], v[100:115]
    v_exp_f32 v122, v122
    v_exp_f32 v123, v123
    v_cvt_pk_bf16_f32 v84, v116, v117
    v_cvt_pk_bf16_f32 v85, v118, v119
    v_mfma_f32_32x32x16_bf16 v[100:115], v[64:67], v[80:83], v[100:115]
    v_exp_f32 v124, v124
    v_exp_f32 v125, v125
    v_cvt_pk_bf16_f32 v86, v120, v121
    v_cvt_pk_bf16_f32 v87, v122, v123
    v_smfmac_f32_16x16x64_bf16 v[96:99], v[92:95], v[76:83], v16
    v_exp_f32 v126, v126
    v_exp_f32 v127, v127
    v_exp_f32 v128, v128
    v_exp_f32 v129, v129
    v_exp_f32 v130, v130
    v_exp_f32 v131, v131
    v_cvt_pk_bf16_f32 v88, v124, v125
    v_cvt_pk_bf16_f32 v89, v126, v127
    v_cvt_pk_bf16_f32 v90, v128, v129
    v_cvt_pk_bf16_f32 v91, v130, v131
    s_waitcnt lgkmcnt(0)
    s_nop 1
    v_mfma_f32_32x32x16_bf16 v[100:115], v[68:71], v[84:87], v[100:115]
    v_mfma_f32_32x32x16_bf16 v[100:115], v[72:75], v[88:91], v[100:115]
    v_smfmac_f32_16x16x64_bf16 v[96:99], v[92:95], v[84:91], v16
    v_mov_b32 v232, 0
    v_mov_b32 v233, 0
    v_mov_b32 v234, 0
    v_mov_b32 v235, 0
    s_waitcnt vmcnt(0)
    s_barrier
    s_cmp_eq_u32 s3, 0
    s_cbranch_scc0 L_w4
    s_add_u32 s93, s59, 4096
    s_mov_b64 exec, 1
    buffer_atomic_add v18, v17, s[16:19], s93 offen sc1
    s_mov_b64 exec, -1
L_w4:
    s_setprio 0
    ds_read_b128 v[44:47], v8 offset:0
    ds_read_b128 v[48:51], v8 offset:1024
    ds_read_b128 v[52:55], v8 offset:4096
    ds_read_b128 v[56:59], v8 offset:5120
    ds_read_b128 v[60:63], v8 offset:2048
    ds_read_b128 v[64:67], v8 offset:3072
    s_waitcnt lgkmcnt(4)
    v_mfma_f32_32x32x16_bf16 v[132:147], v[44:47], v[200:203], v[180:195]
    v_mfma_f32_32x32x16_bf16 v[132:147], v[48:51], v[204:207], v[132:147]
    ds_read_b128 v[44:47], v8 offset:8192
    ds_read_b128 v[48:51], v8 offset:9216
    s_nop 7
    s_nop 1
    s_cmp_eq_u32 s37, 1
    s_cbranch_scc1 L_sw1
L_sk1:
    s_setprio 3
    s_waitcnt lgkmcnt(2)
    v_mfma_f32_32x32x16_bf16 v[116:131], v[52:55], v[200:203], v[164:179]
    v_exp_f32 v132, v132
    v_exp_f32 v133, v133
    v_exp_f32 v134, v134
    v_mfma_f32_32x32x16_bf16 v[116:131], v[56:59], v[204:207], v[116:131]
    v_exp_f32 v135, v135
    v_exp_f32 v136, v136
    v_exp_f32 v137, v137
    ds_read_b128 v[52:55], v8 offset:12288
    ds_read_b128 v[56:59], v8 offset:13312
    v_exp_f32 v138, v138
    v_exp_f32 v139, v139
    v_cvt_pk_bf16_f32 v76, v132, v133
    v_cvt_pk_bf16_f32 v77, v134, v135
    v_exp_f32 v140, v140
    v_exp_f32 v141, v141
    v_cvt_pk_bf16_f32 v78, v136, v137
    v_cvt_pk_bf16_f32 v79, v138, v139
    ds_read_b128 v[68:71], v8 offset:6144
    ds_read_b128 v[72:75], v8 offset:7168
    s_add_u32 m0, s40, 0
    s_add_u32 s93, s39, 196608
    buffer_load_dwordx4 v6, s[16:19], s93 offen offset:0 sc1 lds
    v_exp_f32 v142, v142
    v_exp_f32 v143, v143
    v_exp_f32 v144, v144
    v_exp_f32 v145, v145
    v_exp_f32 v146, v146
    v_exp_f32 v147, v147
    v_cvt_pk_bf16_f32 v80, v140, v141
    v_cvt_pk_bf16_f32 v81, v142, v143
    v_cvt_pk_bf16_f32 v82, v144, v145
    v_cvt_pk_bf16_f32 v83, v146, v147
    s_cmp_eq_u32 s37, 2
    s_cbranch_scc1 L_sw2
L_sk2:
    s_waitcnt lgkmcnt(4)
    v_mfma_f32_32x32x16_bf16 v[132:147], v[44:47], v[200:203], v[164:179]
    v_exp_f32 v116, v116
    v_exp_f32 v117, v117
    v_exp_f32 v118, v118
    v_mfma_f32_32x32x16_bf16 v[132:147], v[48:51], v[204:207], v[132:147]
    v_exp_f32 v119, v119
    v_exp_f32 v120, v120
    v_exp_f32 v121, v121
    ds_read_b128 v[44:47], v8 offset:16384
    ds_read_b128 v[48:51], v8 offset:17408
    v_mfma_f32_32x32x16_bf16 v[216:231], v[60:63], v[76:79], 0
    v_exp_f32 v122, v122
    v_exp_f32 v123, v123
    v_cvt_pk_bf16_f32 v84, v116, v117
    v_cvt_pk_bf16_f32 v85, v118, v119
    v_mfma_f32_32x32x16_bf16 v[216:231], v[64:67], v[80:83], v[216:231]
    v_exp_f32 v124, v124
    v_exp_f32 v125, v125
    v_cvt_pk_bf16_f32 v86, v120, v121
    v_cvt_pk_bf16_f32 v87, v122, v123
    ds_read_b128 v[60:63], v8 offset:10240
    ds_read_b128 v[64:67], v8 offset:11264
    s_add_u32 m0, s40, 0
    s_add_u32 s93, s39, 196608
    buffer_load_dwordx4 v6, s[16:19], s93 offen offset:1024 sc1 lds
    v_smfmac_f32_16x16x64_bf16 v[232:235], v[92:95], v[76:83], v16
    v_exp_f32 v126, v126
    v_exp_f32 v127, v127
    v_exp_f32 v128, v128
    v_exp_f32 v129, v129
    v_exp_f32 v130, v130
    v_exp_f32 v131, v131
    v_cvt_pk_bf16_f32 v88, v124, v125
    v_cvt_pk_bf16_f32 v89, v126, v127
    v_cvt_pk_bf16_f32 v90, v128, v129
    v_cvt_pk_bf16_f32 v91, v130, v131
    s_cmp_eq_u32 s37, 3
    s_cbranch_scc1 L_sw3
L_sk3:
    s_setprio 2
    s_waitcnt lgkmcnt(4)
    v_mfma_f32_32x32x16_bf16 v[116:131], v[52:55], v[200:203], v[164:179]
    v_exp_f32 v132, v132
    v_exp_f32 v133, v133
    v_exp_f32 v134, v134
    v_mfma_f32_32x32x16_bf16 v[116:131], v[56:59], v[204:207], v[116:131]
    v_exp_f32 v135, v135
    v_exp_f32 v136, v136
    v_exp_f32 v137, v137
    ds_read_b128 v[52:55], v8 offset:20480
    ds_read_b128 v[56:59], v8 offset:21504
    v_mfma_f32_32x32x16_bf16 v[216:231], v[68:71], v[84:87], v[216:231]
    v_exp_f32 v138, v138
    v_exp_f32 v139, v139
    v_cvt_pk_bf16_f32 v76, v132, v133
    v_cvt_pk_bf16_f32 v77, v134, v135
    v_mfma_f32_32x32x16_bf16 v[216:231], v[72:75], v[88:91], v[216:231]
    v_exp_f32 v140, v140
    v_exp_f32 v141, v141
    v_cvt_pk_bf16_f32 v78, v136, v137
    v_cvt_pk_bf16_f32 v79, v138, v139
    ds_read_b128 v[68:71], v8 offset:14336
    ds_read_b128 v[72:75], v8 offset:15360
    s_add_u32 m0, s40, 0
    s_add_u32 s93, s39, 196608
    buffer_load_dwordx4 v6, s[16:19], s93 offen offset:2048 sc1 lds
    v_smfmac_f32_16x16x64_bf16 v[232:235], v[92:95], v[84:91], v16
    v_exp_f32 v142, v142
    v_exp_f32 v143, v143
    v_exp_f32 v144, v144
    v_exp_f32 v145, v145
    v_exp_f32 v146, v146
    v_exp_f32 v147, v147
    v_cvt_pk_bf16_f32 v80, v140, v141
    v_cvt_pk_bf16_f32 v81, v142, v143
    v_cvt_pk_bf16_f32 v82, v144, v145
    v_cvt_pk_bf16_f32 v83, v146, v147
    s_cmp_eq_u32 s37, 4
    s_cbranch_scc1 L_sw4
L_sk4:
    s_waitcnt lgkmcnt(4)
    v_mfma_f32_32x32x16_bf16 v[132:147], v[44:47], v[200:203], v[164:179]
    v_exp_f32 v116, v116
    v_exp_f32 v117, v117
    v_exp_f32 v118, v118
    v_mfma_f32_32x32x16_bf16 v[132:147], v[48:51], v[204:207], v[132:147]
    v_exp_f32 v119, v119
    v_exp_f32 v120, v120
    v_exp_f32 v121, v121
    ds_read_b128 v[44:47], v8 offset:24576
    ds_read_b128 v[48:51], v8 offset:25600
    v_mfma_f32_32x32x16_bf16 v[216:231], v[60:63], v[76:79], v[216:231]
    v_exp_f32 v122, v122
    v_exp_f32 v123, v123
    v_cvt_pk_bf16_f32 v84, v116, v117
    v_cvt_pk_bf16_f32 v85, v118, v119
    v_mfma_f32_32x32x16_bf16 v[216:231], v[64:67], v[80:83], v[216:231]
    v_exp_f32 v124, v124
    v_exp_f32 v125, v125
    v_cvt_pk_bf16_f32 v86, v120, v121
    v_cvt_pk_bf16_f32 v87, v122, v123
    ds_read_b128 v[60:63], v8 offset:18432
    ds_read_b128 v[64:67], v8 offset:19456
    s_add_u32 m0, s40, 0
    s_add_u32 s93, s39, 196608
    buffer_load_dwordx4 v6, s[16:19], s93 offen offset:3072 sc1 lds
    v_smfmac_f32_16x16x64_bf16 v[232:235], v[92:95], v[76:83], v16
    v_exp_f32 v126, v126
    v_exp_f32 v127, v127
    v_exp_f32 v128, v128
    v_exp_f32 v129, v129
    v_exp_f32 v130, v130
    v_exp_f32 v131, v131
    v_cvt_pk_bf16_f32 v88, v124, v125
    v_cvt_pk_bf16_f32 v89, v126, v127
    v_cvt_pk_bf16_f32 v90, v128, v129
    v_cvt_pk_bf16_f32 v91, v130, v131
    s_cmp_eq_u32 s37, 5
    s_cbranch_scc1 L_sw5
L_sk5:
    s_setprio 1
    s_waitcnt lgkmcnt(4)
    v_mfma_f32_32x32x16_bf16 v[116:131], v[52:55], v[200:203], v[164:179]
    v_exp_f32 v132, v132
    v_exp_f32 v133, v133
    v_exp_f32 v134, v134
    v_mfma_f32_32x32x16_bf16 v[116:131], v[56:59], v[204:207], v[116:131]
    v_exp_f32 v135, v135
    v_exp_f32 v136, v136
    v_exp_f32 v137, v137
    ds_read_b128 v[52:55], v8 offset:28672
    ds_read_b128 v[56:59], v8 offset:29696
    v_mfma_f32_32x32x16_bf16 v[216:231], v[68:71], v[84:87], v[216:231]
    v_exp_f32 v138, v138
    v_exp_f32 v139, v139
    v_cvt_pk_bf16_f32 v76, v132, v133
    v_cvt_pk_bf16_f32 v77, v134, v135
    v_mfma_f32_32x32x16_bf16 v[216:231], v[72:75], v[88:91], v[216:231]
    v_exp_f32 v140, v140
    v_exp_f32 v141, v141
    v_cvt_pk_bf16_f32 v78, v136, v137
    v_cvt_pk_bf16_f32 v79, v138, v139
    ds_read_b128 v[68:71], v8 offset:22528
    ds_read_b128 v[72:75], v8 offset:23552
    s_add_u32 m0, s40, 32768
    s_add_u32 s93, s39, 229376
    buffer_load_dwordx4 v6, s[16:19], s93 offen offset:0 sc1 lds
    v_smfmac_f32_16x16x64_bf16 v[232:235], v[92:95], v[84:91], v16
    v_exp_f32 v142, v142
    v_exp_f32 v143, v143
    v_exp_f32 v144, v144
    v_exp_f32 v145, v145
    v_exp_f32 v146, v146
    v_exp_f32 v147, v147
    v_cvt_pk_bf16_f32 v80, v140, v141
    v_cvt_pk_bf16_f32 v81, v142, v143
    v_cvt_pk_bf16_f32 v82, v144, v145
    v_cvt_pk_bf16_f32 v83, v146, v147
    s_cmp_eq_u32 s37, 6
    s_cbranch_scc1 L_sw6
L_sk6:
    s_waitcnt lgkmcnt(4)
    v_mfma_f32_32x32x16_bf16 v[132:147], v[44:47], v[200:203], v[164:179]
    v_exp_f32 v116, v116
    v_exp_f32 v117, v117
    v_exp_f32 v118, v118
    v_mfma_f32_32x32x16_bf16 v[132:147], v[48:51], v[204:207], v[132:147]
    v_exp_f32 v119, v119
    v_exp_f32 v120, v120
    v_exp_f32 v121, v121
    ds_read_b128 v[44:47], v8 offset:32768
    ds_read_b128 v[48:51], v8 offset:33792
    v_mfma_f32_32x32x16_bf16 v[216:231], v[60:63], v[76:79], v[216:231]
    v_exp_f32 v122, v122
    v_exp_f32 v123, v123
    v_cvt_pk_bf16_f32 v84, v116, v117
    v_cvt_pk_bf16_f32 v85, v118, v119
    v_mfma_f32_32x32x16_bf16 v[216:231], v[64:67], v[80:83], v[216:231]
    v_exp_f32 v124, v124
    v_exp_f32 v125, v125
    v_cvt_pk_bf16_f32 v86, v120, v121
    v_cvt_pk_bf16_f32 v87, v122, v123
    ds_read_b128 v[60:63], v8 offset:26624
    ds_read_b128 v[64:67], v8 offset:27648
    s_add_u32 m0, s40, 32768
    s_add_u32 s93, s39, 229376
    buffer_load_dwordx4 v6, s[16:19], s93 offen offset:1024 sc1 lds
    v_smfmac_f32_16x16x64_bf16 v[232:235], v[92:95], v[76:83], v16
    v_exp_f32 v126, v126
    v_exp_f32 v127, v127
    v_exp_f32 v128, v128
    v_exp_f32 v129, v129
    v_exp_f32 v130, v130
    v_exp_f32 v131, v131
    v_cvt_pk_bf16_f32 v88, v124, v125
    v_cvt_pk_bf16_f32 v89, v126, v127
    v_cvt_pk_bf16_f32 v90, v128, v129
    v_cvt_pk_bf16_f32 v91, v130, v131
    s_cmp_eq_u32 s37, 7
    s_cbranch_scc1 L_sw7
L_sk7:
    s_setprio 0
    s_waitcnt lgkmcnt(4)
    v_mfma_f32_32x32x16_bf16 v[116:131], v[52:55], v[200:203], v[164:179]
    v_exp_f32 v132, v132
    v_exp_f32 v133, v133
    v_exp_f32 v134, v134
    v_mfma_f32_32x32x16_bf16 v[116:131], v[56:59], v[204:207], v[116:131]
    v_exp_f32 v135, v135
    v_exp_f32 v136, v136
    v_exp_f32 v137, v137
    v_mfma_f32_32x32x16_bf16 v[216:231], v[68:71], v[84:87], v[216:231]
    v_exp_f32 v138, v138
    v_exp_f32 v139, v139
    v_cvt_pk_bf16_f32 v76, v132, v133
    v_cvt_pk_bf16_f32 v77, v134, v135
    v_mfma_f32_32x32x16_bf16 v[216:231], v[72:75], v[88:91], v[216:231]
    v_exp_f32 v140, v140
    v_exp_f32 v141, v141
    v_cvt_pk_bf16_f32 v78, v136, v137
    v_cvt_pk_bf16_f32 v79, v138, v139
    ds_read_b128 v[68:71], v8 offset:30720
    ds_read_b128 v[72:75], v8 offset:31744
    s_add_u32 m0, s40, 32768
    s_add_u32 s93, s39, 229376
    buffer_load_dwordx4 v6, s[16:19], s93 offen offset:2048 sc1 lds
    v_smfmac_f32_16x16x64_bf16 v[232:235], v[92:95], v[84:91], v16
    v_exp_f32 v142, v142
    v_exp_f32 v143, v143
    v_exp_f32 v144, v144
    v_exp_f32 v145, v145
    v_exp_f32 v146, v146
    v_exp_f32 v147, v147
    v_cvt_pk_bf16_f32 v80, v140, v141
    v_cvt_pk_bf16_f32 v81, v142, v143
    v_cvt_pk_bf16_f32 v82, v144, v145
    v_cvt_pk_bf16_f32 v83, v146, v147
    s_waitcnt lgkmcnt(2)
    v_mfma_f32_32x32x16_bf16 v[132:147], v[44:47], v[200:203], v[148:163]
    v_exp_f32 v116, v116
    v_exp_f32 v117, v117
    v_exp_f32 v118, v118
    v_mfma_f32_32x32x16_bf16 v[132:147], v[48:51], v[204:207], v[132:147]
    v_exp_f32 v119, v119
    v_exp_f32 v120, v120
    v_exp_f32 v121, v121
    v_mfma_f32_32x32x16_bf16 v[216:231], v[60:63], v[76:79], v[216:231]
    v_exp_f32 v122, v122
    v_exp_f32 v123, v123
    v_cvt_pk_bf16_f32 v84, v116, v117
    v_cvt_pk_bf16_f32 v85, v118, v119
    v_mfma_f32_32x32x16_bf16 v[216:231], v[64:67], v[80:83], v[216:231]
    v_exp_f32 v124, v124
    v_exp_f32 v125, v125
    v_cvt_pk_bf16_f32 v86, v120, v121
    v_cvt_pk_bf16_f32 v87, v122, v123
    ds_read_b128 v[60:63], v8 offset:34816
    ds_read_b128 v[64:67], v8 offset:35840
    s_add_u32 m0, s40, 32768
    s_add_u32 s93, s39, 229376
    buffer_load_dwordx4 v6, s[16:19], s93 offen offset:3072 sc1 lds
    s_cmp_eq_u32 s3, 0
    s_cbranch_scc0 L_w5
    buffer_load_dword v32, v28, s[16:19], 0 offen sc1
L_w5:
    v_smfmac_f32_16x16x64_bf16 v[232:235], v[92:95], v[76:83], v16
    v_exp_f32 v126, v126
    v_exp_f32 v127, v127
    v_exp_f32 v128, v128
    v_exp_f32 v129, v129
    v_exp_f32 v130, v130
    v_exp_f32 v131, v131
    v_cvt_pk_bf16_f32 v88, v124, v125
    v_cvt_pk_bf16_f32 v89, v126, v127
    v_cvt_pk_bf16_f32 v90, v128, v129
    v_cvt_pk_bf16_f32 v91, v130, v131
    s_waitcnt lgkmcnt(2)
    v_exp_f32 v132, v132
    v_exp_f32 v133, v133
    v_exp_f32 v134, v134
    v_exp_f32 v135, v135
    v_exp_f32 v136, v136
    v_exp_f32 v137, v137
    v_mfma_f32_32x32x16_bf16 v[216:231], v[68:71], v[84:87], v[216:231]
    v_exp_f32 v138, v138
    v_exp_f32 v139, v139
    v_cvt_pk_bf16_f32 v76, v132, v133
    v_cvt_pk_bf16_f32 v77, v134, v135
    v_mfma_f32_32x32x16_bf16 v[216:231], v[72:75], v[88:91], v[216:231]
    v_exp_f32 v140, v140
    v_exp_f32 v141, v141
    v_cvt_pk_bf16_f32 v78, v136, v137
    v_cvt_pk_bf16_f32 v79, v138, v139
    v_smfmac_f32_16x16x64_bf16 v[232:235], v[92:95], v[84:91], v16
    v_exp_f32 v142, v142
    v_exp_f32 v143, v143
    v_exp_f32 v144, v144
    v_exp_f32 v145, v145
    v_exp_f32 v146, v146
    v_exp_f32 v147, v147
    v_cvt_pk_bf16_f32 v80, v140, v141
    v_cvt_pk_bf16_f32 v81, v142, v143
    v_cvt_pk_bf16_f32 v82, v144, v145
    v_cvt_pk_bf16_f32 v83, v146, v147
    s_waitcnt lgkmcnt(0)
    s_nop 1
    v_mfma_f32_32x32x16_bf16 v[216:231], v[60:63], v[76:79], v[216:231]
    v_mfma_f32_32x32x16_bf16 v[216:231], v[64:67], v[80:83], v[216:231]
    v_smfmac_f32_16x16x64_bf16 v[232:235], v[92:95], v[76:83], v16
    s_nop 15
    s_nop 3
    v_add_f32 v232, v232, v233
    v_maximum3_f32 v4, abs(v216), abs(v217), abs(v232)
    v_maximum3_f32 v4, abs(v218), abs(v219), v4
    v_maximum3_f32 v4, abs(v220), abs(v221), v4
    v_maximum3_f32 v4, abs(v222), abs(v223), v4
    v_maximum3_f32 v4, abs(v224), abs(v225), v4
    v_maximum3_f32 v4, abs(v226), abs(v227), v4
    v_maximum3_f32 v4, abs(v228), abs(v229), v4
    v_maximum3_f32 v4, abs(v230), abs(v231), v4
    s_mov_b32 s93, 0x7f000000
    s_mov_b32 s94, 0x21800000
    v_cmp_gt_f32 vcc, s93, v4
    v_cmp_le_f32 s[60:61], s94, v232
    s_mov_b32 s93, 0x5d800000
    v_cmp_ge_f32 s[62:63], s93, v232
    s_nop 3
    s_and_b64 vcc, vcc, s[60:61]
    s_and_b64 vcc, vcc, s[62:63]
    s_cmp_eq_u64 vcc, exec
    s_cbranch_scc0 L_fbA
L_stA:
    v_rcp_f32 v4, v232
    s_nop 0
    v_mul_f32 v4, v13, v4
    v_mov_b32 v5, v4
    v_pk_mul_f32 v[216:217], v[216:217], v[4:5]
    v_pk_mul_f32 v[218:219], v[218:219], v[4:5]
    v_pk_mul_f32 v[220:221], v[220:221], v[4:5]
    v_pk_mul_f32 v[222:223], v[222:223], v[4:5]
    v_pk_mul_f32 v[224:225], v[224:225], v[4:5]
    v_pk_mul_f32 v[226:227], v[226:227], v[4:5]
    v_pk_mul_f32 v[228:229], v[228:229], v[4:5]
    v_pk_mul_f32 v[230:231], v[230:231], v[4:5]
    v_cvt_pk_bf16_f32 v208, v216, v217
    v_cvt_pk_bf16_f32 v209, v218, v219
    v_cvt_pk_bf16_f32 v210, v220, v221
    v_cvt_pk_bf16_f32 v211, v222, v223
    v_cvt_pk_bf16_f32 v212, v224, v225
    v_cvt_pk_bf16_f32 v213, v226, v227
    v_cvt_pk_bf16_f32 v214, v228, v229
    v_cvt_pk_bf16_f32 v215, v230, v231
    buffer_store_dwordx4 v[208:211], v9, s[16:19], s44 offen sc1
    buffer_store_dwordx4 v[212:215], v9, s[16:19], s44 offen offset:512 sc1
    s_cmp_eq_u32 s3, 0
    s_cbranch_scc0 L_c6
    s_waitcnt vmcnt(2)
    v_cmp_le_u32 vcc, 32, v32
    s_nop 3
    s_cmp_eq_u64 vcc, exec
    s_cbranch_scc0 L_s6
L_c6:
    s_waitcnt vmcnt(6)
    s_barrier
    ds_read_b128 v[44:47], v6 offset:0
    ds_read_b128 v[48:51], v6 offset:1024
    ds_read_b128 v[52:55], v6 offset:4096
    ds_read_b128 v[56:59], v6 offset:5120
    ds_read_b128 v[60:63], v6 offset:2048
    ds_read_b128 v[64:67], v6 offset:3072
    s_waitcnt lgkmcnt(4)
    v_mfma_f32_32x32x16_bf16 v[132:147], v[44:47], v[36:39], 0
    v_mfma_f32_32x32x16_bf16 v[132:147], v[48:51], v[40:43], v[132:147]
    ds_read_b128 v[44:47], v6 offset:8192
    ds_read_b128 v[48:51], v6 offset:9216
    s_nop 7
    s_nop 1
    s_setprio 2
    s_waitcnt lgkmcnt(2)
    v_mfma_f32_32x32x16_bf16 v[116:131], v[52:55], v[36:39], 0
    v_exp_f32 v132, v132
    v_exp_f32 v133, v133
    v_exp_f32 v134, v134
    v_mfma_f32_32x32x16_bf16 v[116:131], v[56:59], v[40:43], v[116:131]
    v_exp_f32 v135, v135
    v_exp_f32 v136, v136
    v_exp_f32 v137, v137
    ds_read_b128 v[52:55], v6 offset:12288
    ds_read_b128 v[56:59], v6 offset:13312
    v_exp_f32 v138, v138
    v_exp_f32 v139, v139
    v_cvt_pk_bf16_f32 v76, v132, v133
    v_cvt_pk_bf16_f32 v77, v134, v135
    v_exp_f32 v140, v140
    v_exp_f32 v141, v141
    v_cvt_pk_bf16_f32 v78, v136, v137
    v_cvt_pk_bf16_f32 v79, v138, v139
    ds_read_b128 v[68:71], v6 offset:6144
    ds_read_b128 v[72:75], v6 offset:7168
    s_add_u32 m0, s40, 65536
    s_add_u32 s93, s58, 0
    buffer_load_dwordx4 v6, s[16:19], s93 offen offset:0 sc1 lds
    v_exp_f32 v142, v142
    v_exp_f32 v143, v143
    v_exp_f32 v144, v144
    v_exp_f32 v145, v145
    v_exp_f32 v146, v146
    v_exp_f32 v147, v147
    v_cvt_pk_bf16_f32 v80, v140, v141
    v_cvt_pk_bf16_f32 v81, v142, v143
    v_cvt_pk_bf16_f32 v82, v144, v145
    v_cvt_pk_bf16_f32 v83, v146, v147
    s_setprio 1
    s_waitcnt lgkmcnt(4)
    v_mfma_f32_32x32x16_bf16 v[132:147], v[44:47], v[36:39], 0
    v_exp_f32 v116, v116
    v_exp_f32 v117, v117
    v_exp_f32 v118, v118
    v_mfma_f32_32x32x16_bf16 v[132:147], v[48:51], v[40:43], v[132:147]
    v_exp_f32 v119, v119
    v_exp_f32 v120, v120
    v_exp_f32 v121, v121
    ds_read_b128 v[44:47], v6 offset:16384
    ds_read_b128 v[48:51], v6 offset:17408
    v_mfma_f32_32x32x16_bf16 v[100:115], v[60:63], v[76:79], v[100:115]
    v_exp_f32 v122, v122
    v_exp_f32 v123, v123
    v_cvt_pk_bf16_f32 v84, v116, v117
    v_cvt_pk_bf16_f32 v85, v118, v119
    v_mfma_f32_32x32x16_bf16 v[100:115], v[64:67], v[80:83], v[100:115]
    v_exp_f32 v124, v124
    v_exp_f32 v125, v125
    v_cvt_pk_bf16_f32 v86, v120, v121
    v_cvt_pk_bf16_f32 v87, v122, v123
    ds_read_b128 v[60:63], v6 offset:10240
    ds_read_b128 v[64:67], v6 offset:11264
    s_add_u32 m0, s40, 65536
    s_add_u32 s93, s58, 0
    buffer_load_dwordx4 v6, s[16:19], s93 offen offset:1024 sc1 lds
    v_smfmac_f32_16x16x64_bf16 v[96:99], v[92:95], v[76:83], v16
    v_exp_f32 v126, v126
    v_exp_f32 v127, v127
    v_exp_f32 v128, v128
    v_exp_f32 v129, v129
    v_exp_f32 v130, v130
    v_exp_f32 v131, v131
    v_cvt_pk_bf16_f32 v88, v124, v125
    v_cvt_pk_bf16_f32 v89, v126, v127
    v_cvt_pk_bf16_f32 v90, v128, v129
    v_cvt_pk_bf16_f32 v91, v130, v131
    s_setprio 0
    s_waitcnt lgkmcnt(4)
    v_mfma_f32_32x32x16_bf16 v[116:131], v[52:55], v[36:39], 0
    v_exp_f32 v132, v132
    v_exp_f32 v133, v133
    v_exp_f32 v134, v134
    v_mfma_f32_32x32x16_bf16 v[116:131], v[56:59], v[40:43], v[116:131]
    v_exp_f32 v135, v135
    v_exp_f32 v136, v136
    v_exp_f32 v137, v137
    ds_read_b128 v[52:55], v6 offset:20480
    ds_read_b128 v[56:59], v6 offset:21504
    v_mfma_f32_32x32x16_bf16 v[100:115], v[68:71], v[84:87], v[100:115]
    v_exp_f32 v138, v138
    v_exp_f32 v139, v139
    v_cvt_pk_bf16_f32 v76, v132, v133
    v_cvt_pk_bf16_f32 v77, v134, v135
    v_mfma_f32_32x32x16_bf16 v[100:115], v[72:75], v[88:91], v[100:115]
    v_exp_f32 v140, v140
    v_exp_f32 v141, v141
    v_cvt_pk_bf16_f32 v78, v136, v137
    v_cvt_pk_bf16_f32 v79, v138, v139
    ds_read_b128 v[68:71], v6 offset:14336
    ds_read_b128 v[72:75], v6 offset:15360
    s_add_u32 m0, s40, 65536
    s_add_u32 s93, s58, 0
    buffer_load_dwordx4 v6, s[16:19], s93 offen offset:2048 sc1 lds
    v_smfmac_f32_16x16x64_bf16 v[96:99], v[92:95], v[84:91], v16
    v_exp_f32 v142, v142
    v_exp_f32 v143, v143
    v_exp_f32 v144, v144
    v_exp_f32 v145, v145
    v_exp_f32 v146, v146
    v_exp_f32 v147, v147
    v_cvt_pk_bf16_f32 v80, v140, v141
    v_cvt_pk_bf16_f32 v81, v142, v143
    v_cvt_pk_bf16_f32 v82, v144, v145
    v_cvt_pk_bf16_f32 v83, v146, v147
    s_waitcnt vmcnt(3)
    s_barrier
    s_setprio 3
    s_waitcnt lgkmcnt(4)
    v_mfma_f32_32x32x16_bf16 v[132:147], v[44:47], v[36:39], 0
    v_exp_f32 v116, v116
    v_exp_f32 v117, v117
    v_exp_f32 v118, v118
    v_mfma_f32_32x32x16_bf16 v[132:147], v[48:51], v[40:43], v[132:147]
    v_exp_f32 v119, v119
    v_exp_f32 v120, v120
    v_exp_f32 v121, v121
    ds_read_b128 v[44:47], v6 offset:24576
    ds_read_b128 v[48:51], v6 offset:25600
    v_mfma_f32_32x32x16_bf16 v[100:115], v[60:63], v[76:79], v[100:115]
    v_exp_f32 v122, v122
    v_exp_f32 v123, v123
    v_cvt_pk_bf16_f32 v84, v116, v117
    v_cvt_pk_bf16_f32 v85, v118, v119
    v_mfma_f32_32x32x16_bf16 v[100:115], v[64:67], v[80:83], v[100:115]
    v_exp_f32 v124, v124
    v_exp_f32 v125, v125
    v_cvt_pk_bf16_f32 v86, v120, v121
    v_cvt_pk_bf16_f32 v87, v122, v123
    ds_read_b128 v[60:63], v6 offset:18432
    ds_read_b128 v[64:67], v6 offset:19456
    s_add_u32 m0, s40, 65536
    s_add_u32 s93, s58, 0
    buffer_load_dwordx4 v6, s[16:19], s93 offen offset:3072 sc1 lds
    s_cmp_eq_u32 s3, 0
    s_cbranch_scc0 L_w7
    s_mov_b64 exec, 1
    buffer_atomic_add v18, v17, s[16:19], s59 offen offset:2048 sc1
    s_mov_b64 exec, -1
L_w7:
    v_smfmac_f32_16x16x64_bf16 v[96:99], v[92:95], v[76:83], v16
    v_exp_f32 v126, v126
    v_exp_f32 v127, v127
    v_exp_f32 v128, v128
    v_exp_f32 v129, v129
    v_exp_f32 v130, v130
    v_exp_f32 v131, v131
    v_cvt_pk_bf16_f32 v88, v124, v125
    v_cvt_pk_bf16_f32 v89, v126, v127
    v_cvt_pk_bf16_f32 v90, v128, v129
    v_cvt_pk_bf16_f32 v91, v130, v131
    s_setprio 2
    s_waitcnt lgkmcnt(4)
    v_mfma_f32_32x32x16_bf16 v[116:131], v[52:55], v[36:39], 0
    v_exp_f32 v132, v132
    v_exp_f32 v133, v133
    v_exp_f32 v134, v134
    v_mfma_f32_32x32x16_bf16 v[116:131], v[56:59], v[40:43], v[116:131]
    v_exp_f32 v135, v135
    v_exp_f32 v136, v136
    v_exp_f32 v137, v137
    ds_read_b128 v[52:55], v6 offset:28672
    ds_read_b128 v[56:59], v6 offset:29696
    v_mfma_f32_32x32x16_bf16 v[100:115], v[68:71], v[84:87], v[100:115]
    v_exp_f32 v138, v138
    v_exp_f32 v139, v139
    v_cvt_pk_bf16_f32 v76, v132, v133
    v_cvt_pk_bf16_f32 v77, v134, v135
    v_mfma_f32_32x32x16_bf16 v[100:115], v[72:75], v[88:91], v[100:115]
    v_exp_f32 v140, v140
    v_exp_f32 v141, v141
    v_cvt_pk_bf16_f32 v78, v136, v137
    v_cvt_pk_bf16_f32 v79, v138, v139
    ds_read_b128 v[68:71], v6 offset:22528
    ds_read_b128 v[72:75], v6 offset:23552
    s_add_u32 m0, s40, 98304
    s_add_u32 s93, s58, 32768
    buffer_load_dwordx4 v6, s[16:19], s93 offen offset:0 sc1 lds
    v_smfmac_f32_16x16x64_bf16 v[96:99], v[92:95], v[84:91], v16
    v_exp_f32 v142, v142
    v_exp_f32 v143, v143
    v_exp_f32 v144, v144
    v_exp_f32 v145, v145
    v_exp_f32 v146, v146
    v_exp_f32 v147, v147
    v_cvt_pk_bf16_f32 v80, v140, v141
    v_cvt_pk_bf16_f32 v81, v142, v143
    v_cvt_pk_bf16_f32 v82, v144, v145
    v_cvt_pk_bf16_f32 v83, v146, v147
    s_setprio 1
    s_waitcnt lgkmcnt(4)
    v_mfma_f32_32x32x16_bf16 v[132:147], v[44:47], v[36:39], 0
    v_exp_f32 v116, v116
    v_exp_f32 v117, v117
    v_exp_f32 v118, v118
    v_mfma_f32_32x32x16_bf16 v[132:147], v[48:51], v[40:43], v[132:147]
    v_exp_f32 v119, v119
    v_exp_f32 v120, v120
    v_exp_f32 v121, v121
    ds_read_b128 v[44:47], v6 offset:32768
    ds_read_b128 v[48:51], v6 offset:33792
    v_mfma_f32_32x32x16_bf16 v[100:115], v[60:63], v[76:79], v[100:115]
    v_exp_f32 v122, v122
    v_exp_f32 v123, v123
    v_cvt_pk_bf16_f32 v84, v116, v117
    v_cvt_pk_bf16_f32 v85, v118, v119
    v_mfma_f32_32x32x16_bf16 v[100:115], v[64:67], v[80:83], v[100:115]
    v_exp_f32 v124, v124
    v_exp_f32 v125, v125
    v_cvt_pk_bf16_f32 v86, v120, v121
    v_cvt_pk_bf16_f32 v87, v122, v123
    ds_read_b128 v[60:63], v6 offset:26624
    ds_read_b128 v[64:67], v6 offset:27648
    s_add_u32 m0, s40, 98304
    s_add_u32 s93, s58, 32768
    buffer_load_dwordx4 v6, s[16:19], s93 offen offset:1024 sc1 lds
    v_smfmac_f32_16x16x64_bf16 v[96:99], v[92:95], v[76:83], v16
    v_exp_f32 v126, v126
    v_exp_f32 v127, v127
    v_exp_f32 v128, v128
    v_exp_f32 v129, v129
    v_exp_f32 v130, v130
    v_exp_f32 v131, v131
    v_cvt_pk_bf16_f32 v88, v124, v125
    v_cvt_pk_bf16_f32 v89, v126, v127
    v_cvt_pk_bf16_f32 v90, v128, v129
    v_cvt_pk_bf16_f32 v91, v130, v131
    s_setprio 0
    s_waitcnt lgkmcnt(4)
    v_mfma_f32_32x32x16_bf16 v[116:131], v[52:55], v[36:39], 0
    v_exp_f32 v132, v132
    v_exp_f32 v133, v133
    v_exp_f32 v134, v134
    v_mfma_f32_32x32x16_bf16 v[116:131], v[56:59], v[40:43], v[116:131]
    v_exp_f32 v135, v135
    v_exp_f32 v136, v136
    v_exp_f32 v137, v137
    ds_read_b128 v[52:55], v6 offset:36864
    ds_read_b128 v[56:59], v6 offset:37888
    v_mfma_f32_32x32x16_bf16 v[100:115], v[68:71], v[84:87], v[100:115]
    v_exp_f32 v138, v138
    v_exp_f32 v139, v139
    v_cvt_pk_bf16_f32 v76, v132, v133
    v_cvt_pk_bf16_f32 v77, v134, v135
    v_mfma_f32_32x32x16_bf16 v[100:115], v[72:75], v[88:91], v[100:115]
    v_exp_f32 v140, v140
    v_exp_f32 v141, v141
    v_cvt_pk_bf16_f32 v78, v136, v137
    v_cvt_pk_bf16_f32 v79, v138, v139
    ds_read_b128 v[68:71], v6 offset:30720
    ds_read_b128 v[72:75], v6 offset:31744
    s_add_u32 m0, s40, 98304
    s_add_u32 s93, s58, 32768
    buffer_load_dwordx4 v6, s[16:19], s93 offen offset:2048 sc1 lds
    s_cmp_eq_u32 s3, 0
    s_cbranch_scc0 L_w8
    buffer_load_dword v32, v17, s[16:19], s28 offen offset:2048 sc1
L_w8:
    v_smfmac_f32_16x16x64_bf16 v[96:99], v[92:95], v[84:91], v16
    v_exp_f32 v142, v142
    v_exp_f32 v143, v143
    v_exp_f32 v144, v144
    v_exp_f32 v145, v145
    v_exp_f32 v146, v146
    v_exp_f32 v147, v147
    v_cvt_pk_bf16_f32 v80, v140, v141
    v_cvt_pk_bf16_f32 v81, v142, v143
    v_cvt_pk_bf16_f32 v82, v144, v145
    v_cvt_pk_bf16_f32 v83, v146, v147
    s_waitcnt lgkmcnt(4)
    v_mfma_f32_32x32x16_bf16 v[132:147], v[44:47], v[36:39], 0
    v_exp_f32 v116, v116
    v_exp_f32 v117, v117
    v_exp_f32 v118, v118
    v_mfma_f32_32x32x16_bf16 v[132:147], v[48:51], v[40:43], v[132:147]
    v_exp_f32 v119, v119
    v_exp_f32 v120, v120
    v_exp_f32 v121, v121
    ds_read_b128 v[44:47], v6 offset:40960
    ds_read_b128 v[48:51], v6 offset:41984
    v_mfma_f32_32x32x16_bf16 v[100:115], v[60:63], v[76:79], v[100:115]
    v_exp_f32 v122, v122
    v_exp_f32 v123, v123
    v_cvt_pk_bf16_f32 v84, v116, v117
    v_cvt_pk_bf16_f32 v85, v118, v119
    v_mfma_f32_32x32x16_bf16 v[100:115], v[64:67], v[80:83], v[100:115]
    v_exp_f32 v124, v124
    v_exp_f32 v125, v125
    v_cvt_pk_bf16_f32 v86, v120, v121
    v_cvt_pk_bf16_f32 v87, v122, v123
    ds_read_b128 v[60:63], v6 offset:34816
    ds_read_b128 v[64:67], v6 offset:35840
    s_add_u32 m0, s40, 98304
    s_add_u32 s93, s58, 32768
    buffer_load_dwordx4 v6, s[16:19], s93 offen offset:3072 sc1 lds
    v_smfmac_f32_16x16x64_bf16 v[96:99], v[92:95], v[76:83], v16
    v_exp_f32 v126, v126
    v_exp_f32 v127, v127
    v_exp_f32 v128, v128
    v_exp_f32 v129, v129
    v_exp_f32 v130, v130
    v_exp_f32 v131, v131
    v_cvt_pk_bf16_f32 v88, v124, v125
    v_cvt_pk_bf16_f32 v89, v126, v127
    v_cvt_pk_bf16_f32 v90, v128, v129
    v_cvt_pk_bf16_f32 v91, v130, v131
    s_cmp_eq_u32 s3, 0
    s_cbranch_scc0 L_c9
    s_waitcnt vmcnt(1)
    v_readfirstlane_b32 s93, v32
    s_cmp_ge_u32 s93, 32
    s_cbranch_scc0 L_s9
L_c9:
    s_waitcnt lgkmcnt(4)
    s_waitcnt vmcnt(4)
    s_barrier
    s_setprio 3
    s_waitcnt lgkmcnt(4)
    v_mfma_f32_32x32x16_bf16 v[116:131], v[52:55], v[36:39], 0
    v_exp_f32 v132, v132
    v_exp_f32 v133, v133
    v_exp_f32 v134, v134
    v_mfma_f32_32x32x16_bf16 v[116:131], v[56:59], v[40:43], v[116:131]
    v_exp_f32 v135, v135
    v_exp_f32 v136, v136
    v_exp_f32 v137, v137
    ds_read_b128 v[52:55], v6 offset:45056
    ds_read_b128 v[56:59], v6 offset:46080
    v_mfma_f32_32x32x16_bf16 v[100:115], v[68:71], v[84:87], v[100:115]
    v_exp_f32 v138, v138
    v_exp_f32 v139, v139
    v_cvt_pk_bf16_f32 v76, v132, v133
    v_cvt_pk_bf16_f32 v77, v134, v135
    v_mfma_f32_32x32x16_bf16 v[100:115], v[72:75], v[88:91], v[100:115]
    v_exp_f32 v140, v140
    v_exp_f32 v141, v141
    v_cvt_pk_bf16_f32 v78, v136, v137
    v_cvt_pk_bf16_f32 v79, v138, v139
    ds_read_b128 v[68:71], v6 offset:38912
    ds_read_b128 v[72:75], v6 offset:39936
    s_add_u32 s94, s57, 0
    buffer_load_dwordx4 v[148:151], v19, s[16:19], s94 offen sc1
    s_add_u32 s94, s57, 0
    buffer_load_dwordx4 v[152:155], v20, s[16:19], s94 offen sc1
    s_add_u32 s94, s57, 262144
    buffer_load_dwordx4 v[156:159], v19, s[16:19], s94 offen sc1
    v_smfmac_f32_16x16x64_bf16 v[96:99], v[92:95], v[84:91], v16
    v_exp_f32 v142, v142
    v_exp_f32 v143, v143
    v_exp_f32 v144, v144
    v_exp_f32 v145, v145
    v_exp_f32 v146, v146
    v_exp_f32 v147, v147
    v_cvt_pk_bf16_f32 v80, v140, v141
    v_cvt_pk_bf16_f32 v81, v142, v143
    v_cvt_pk_bf16_f32 v82, v144, v145
    v_cvt_pk_bf16_f32 v83, v146, v147
    s_waitcnt lgkmcnt(4)
    v_mfma_f32_32x32x16_bf16 v[132:147], v[44:47], v[36:39], 0
    v_exp_f32 v116, v116
    v_exp_f32 v117, v117
    v_exp_f32 v118, v118
    v_mfma_f32_32x32x16_bf16 v[132:147], v[48:51], v[40:43], v[132:147]
    v_exp_f32 v119, v119
    v_exp_f32 v120, v120
    v_exp_f32 v121, v121
    ds_read_b128 v[44:47], v6 offset:49152
    ds_read_b128 v[48:51], v6 offset:50176
    v_mfma_f32_32x32x16_bf16 v[100:115], v[60:63], v[76:79], v[100:115]
    v_exp_f32 v122, v122
    v_exp_f32 v123, v123
    v_cvt_pk_bf16_f32 v84, v116, v117
    v_cvt_pk_bf16_f32 v85, v118, v119
    v_mfma_f32_32x32x16_bf16 v[100:115], v[64:67], v[80:83], v[100:115]
    v_exp_f32 v124, v124
    v_exp_f32 v125, v125
    v_cvt_pk_bf16_f32 v86, v120, v121
    v_cvt_pk_bf16_f32 v87, v122, v123
    ds_read_b128 v[60:63], v6 offset:43008
    ds_read_b128 v[64:67], v6 offset:44032
    s_add_u32 s94, s57, 262144
    buffer_load_dwordx4 v[160:163], v20, s[16:19], s94 offen sc1
    s_add_u32 s94, s57, 524288
    buffer_load_dwordx4 v[164:167], v19, s[16:19], s94 offen sc1
    s_add_u32 s94, s57, 524288
    buffer_load_dwordx4 v[168:171], v20, s[16:19], s94 offen sc1
    v_smfmac_f32_16x16x64_bf16 v[96:99], v[92:95], v[76:83], v16
    v_exp_f32 v126, v126
    v_exp_f32 v127, v127
    v_exp_f32 v128, v128
    v_exp_f32 v129, v129
    v_exp_f32 v130, v130
    v_exp_f32 v131, v131
    v_cvt_pk_bf16_f32 v88, v124, v125
    v_cvt_pk_bf16_f32 v89, v126, v127
    v_cvt_pk_bf16_f32 v90, v128, v129
    v_cvt_pk_bf16_f32 v91, v130, v131
    s_setprio 2
    s_waitcnt lgkmcnt(4)
    v_mfma_f32_32x32x16_bf16 v[116:131], v[52:55], v[36:39], 0
    v_exp_f32 v132, v132
    v_exp_f32 v133, v133
    v_exp_f32 v134, v134
    v_mfma_f32_32x32x16_bf16 v[116:131], v[56:59], v[40:43], v[116:131]
    v_exp_f32 v135, v135
    v_exp_f32 v136, v136
    v_exp_f32 v137, v137
    ds_read_b128 v[52:55], v6 offset:53248
    ds_read_b128 v[56:59], v6 offset:54272
    v_mfma_f32_32x32x16_bf16 v[100:115], v[68:71], v[84:87], v[100:115]
    v_exp_f32 v138, v138
    v_exp_f32 v139, v139
    v_cvt_pk_bf16_f32 v76, v132, v133
    v_cvt_pk_bf16_f32 v77, v134, v135
    v_mfma_f32_32x32x16_bf16 v[100:115], v[72:75], v[88:91], v[100:115]
    v_exp_f32 v140, v140
    v_exp_f32 v141, v141
    v_cvt_pk_bf16_f32 v78, v136, v137
    v_cvt_pk_bf16_f32 v79, v138, v139
    ds_read_b128 v[68:71], v6 offset:47104
    ds_read_b128 v[72:75], v6 offset:48128
    s_add_u32 s94, s57, 786432
    buffer_load_dwordx4 v[172:175], v19, s[16:19], s94 offen sc1
    s_add_u32 s94, s57, 786432
    buffer_load_dwordx4 v[176:179], v20, s[16:19], s94 offen sc1
    s_add_u32 s94, s57, 1048576
    buffer_load_dwordx4 v[180:183], v19, s[16:19], s94 offen sc1
    v_smfmac_f32_16x16x64_bf16 v[96:99], v[92:95], v[84:91], v16
    v_exp_f32 v142, v142
    v_exp_f32 v143, v143
    v_exp_f32 v144, v144
    v_exp_f32 v145, v145
    v_exp_f32 v146, v146
    v_exp_f32 v147, v147
    v_cvt_pk_bf16_f32 v80, v140, v141
    v_cvt_pk_bf16_f32 v81, v142, v143
    v_cvt_pk_bf16_f32 v82, v144, v145
    v_cvt_pk_bf16_f32 v83, v146, v147
    s_waitcnt lgkmcnt(4)
    v_mfma_f32_32x32x16_bf16 v[132:147], v[44:47], v[36:39], 0
    v_exp_f32 v116, v116
    v_exp_f32 v117, v117
    v_exp_f32 v118, v118
    v_mfma_f32_32x32x16_bf16 v[132:147], v[48:51], v[40:43], v[132:147]
    v_exp_f32 v119, v119
    v_exp_f32 v120, v120
    v_exp_f32 v121, v121
    ds_read_b128 v[44:47], v6 offset:57344
    ds_read_b128 v[48:51], v6 offset:58368
    v_mfma_f32_32x32x16_bf16 v[100:115], v[60:63], v[76:79], v[100:115]
    v_exp_f32 v122, v122
    v_exp_f32 v123, v123
    v_cvt_pk_bf16_f32 v84, v116, v117
    v_cvt_pk_bf16_f32 v85, v118, v119
    v_mfma_f32_32x32x16_bf16 v[100:115], v[64:67], v[80:83], v[100:115]
    v_exp_f32 v124, v124
    v_exp_f32 v125, v125
    v_cvt_pk_bf16_f32 v86, v120, v121
    v_cvt_pk_bf16_f32 v87, v122, v123
    ds_read_b128 v[60:63], v6 offset:51200
    ds_read_b128 v[64:67], v6 offset:52224
    s_add_u32 s94, s57, 1048576
    buffer_load_dwordx4 v[184:187], v20, s[16:19], s94 offen sc1
    s_add_u32 s94, s57, 1310720
    buffer_load_dwordx4 v[188:191], v19, s[16:19], s94 offen sc1
    s_add_u32 s94, s57, 1310720
    buffer_load_dwordx4 v[192:195], v20, s[16:19], s94 offen sc1
    v_smfmac_f32_16x16x64_bf16 v[96:99], v[92:95], v[76:83], v16
    v_exp_f32 v126, v126
    v_exp_f32 v127, v127
    v_exp_f32 v128, v128
    v_exp_f32 v129, v129
    v_exp_f32 v130, v130
    v_exp_f32 v131, v131
    v_cvt_pk_bf16_f32 v88, v124, v125
    v_cvt_pk_bf16_f32 v89, v126, v127
    v_cvt_pk_bf16_f32 v90, v128, v129
    v_cvt_pk_bf16_f32 v91, v130, v131
    s_setprio 1
    s_waitcnt lgkmcnt(4)
    v_mfma_f32_32x32x16_bf16 v[116:131], v[52:55], v[36:39], 0
    v_exp_f32 v132, v132
    v_exp_f32 v133, v133
    v_exp_f32 v134, v134
    v_mfma_f32_32x32x16_bf16 v[116:131], v[56:59], v[40:43], v[116:131]
    v_exp_f32 v135, v135
    v_exp_f32 v136, v136
    v_exp_f32 v137, v137
    ds_read_b128 v[52:55], v6 offset:61440
    ds_read_b128 v[56:59], v6 offset:62464
    v_mfma_f32_32x32x16_bf16 v[100:115], v[68:71], v[84:87], v[100:115]
    v_exp_f32 v138, v138
    v_exp_f32 v139, v139
    v_cvt_pk_bf16_f32 v76, v132, v133
    v_cvt_pk_bf16_f32 v77, v134, v135
    v_mfma_f32_32x32x16_bf16 v[100:115], v[72:75], v[88:91], v[100:115]
    v_exp_f32 v140, v140
    v_exp_f32 v141, v141
    v_cvt_pk_bf16_f32 v78, v136, v137
    v_cvt_pk_bf16_f32 v79, v138, v139
    ds_read_b128 v[68:71], v6 offset:55296
    ds_read_b128 v[72:75], v6 offset:56320
    s_add_u32 s94, s57, 1572864
    buffer_load_dwordx4 v[200:203], v19, s[16:19], s94 offen sc1
    s_add_u32 s94, s57, 1572864
    buffer_load_dwordx4 v[204:207], v20, s[16:19], s94 offen sc1
    s_add_u32 s94, s57, 1835008
    buffer_load_dwordx4 v[208:211], v19, s[16:19], s94 offen sc1
    v_smfmac_f32_16x16x64_bf16 v[96:99], v[92:95], v[84:91], v16
    v_exp_f32 v142, v142
    v_exp_f32 v143, v143
    v_exp_f32 v144, v144
    v_exp_f32 v145, v145
    v_exp_f32 v146, v146
    v_exp_f32 v147, v147
    v_cvt_pk_bf16_f32 v80, v140, v141
    v_cvt_pk_bf16_f32 v81, v142, v143
    v_cvt_pk_bf16_f32 v82, v144, v145
    v_cvt_pk_bf16_f32 v83, v146, v147
    s_waitcnt lgkmcnt(4)
    v_mfma_f32_32x32x16_bf16 v[132:147], v[44:47], v[36:39], 0
    v_exp_f32 v116, v116
    v_exp_f32 v117, v117
    v_exp_f32 v118, v118
    v_mfma_f32_32x32x16_bf16 v[132:147], v[48:51], v[40:43], v[132:147]
    v_exp_f32 v119, v119
    v_exp_f32 v120, v120
    v_exp_f32 v121, v121
    v_mfma_f32_32x32x16_bf16 v[100:115], v[60:63], v[76:79], v[100:115]
    v_exp_f32 v122, v122
    v_exp_f32 v123, v123
    v_cvt_pk_bf16_f32 v84, v116, v117
    v_cvt_pk_bf16_f32 v85, v118, v119
    v_mfma_f32_32x32x16_bf16 v[100:115], v[64:67], v[80:83], v[100:115]
    v_exp_f32 v124, v124
    v_exp_f32 v125, v125
    v_cvt_pk_bf16_f32 v86, v120, v121
    v_cvt_pk_bf16_f32 v87, v122, v123
    ds_read_b128 v[60:63], v6 offset:59392
    ds_read_b128 v[64:67], v6 offset:60416
    s_add_u32 s94, s57, 1835008
    buffer_load_dwordx4 v[212:215], v20, s[16:19], s94 offen sc1
    s_add_u32 s94, s57, 2097152
    buffer_load_dwordx4 v[216:219], v19, s[16:19], s94 offen sc1
    s_add_u32 s94, s57, 2097152
    buffer_load_dwordx4 v[220:223], v20, s[16:19], s94 offen sc1
    v_smfmac_f32_16x16x64_bf16 v[96:99], v[92:95], v[76:83], v16
    v_exp_f32 v126, v126
    v_exp_f32 v127, v127
    v_exp_f32 v128, v128
    v_exp_f32 v129, v129
    v_exp_f32 v130, v130
    v_exp_f32 v131, v131
    v_cvt_pk_bf16_f32 v88, v124, v125
    v_cvt_pk_bf16_f32 v89, v126, v127
    v_cvt_pk_bf16_f32 v90, v128, v129
    v_cvt_pk_bf16_f32 v91, v130, v131
    s_setprio 0
    s_waitcnt lgkmcnt(2)
    v_mfma_f32_32x32x16_bf16 v[116:131], v[52:55], v[36:39], 0
    v_exp_f32 v132, v132
    v_exp_f32 v133, v133
    v_exp_f32 v134, v134
    v_mfma_f32_32x32x16_bf16 v[116:131], v[56:59], v[40:43], v[116:131]
    v_exp_f32 v135, v135
    v_exp_f32 v136, v136
    v_exp_f32 v137, v137
    v_mfma_f32_32x32x16_bf16 v[100:115], v[68:71], v[84:87], v[100:115]
    v_exp_f32 v138, v138
    v_exp_f32 v139, v139
    v_cvt_pk_bf16_f32 v76, v132, v133
    v_cvt_pk_bf16_f32 v77, v134, v135
    v_mfma_f32_32x32x16_bf16 v[100:115], v[72:75], v[88:91], v[100:115]
    v_exp_f32 v140, v140
    v_exp_f32 v141, v141
    v_cvt_pk_bf16_f32 v78, v136, v137
    v_cvt_pk_bf16_f32 v79, v138, v139
    ds_read_b128 v[68:71], v6 offset:63488
    ds_read_b128 v[72:75], v6 offset:64512
    s_add_u32 s94, s57, 2359296
    buffer_load_dwordx4 v[224:227], v19, s[16:19], s94 offen sc1
    s_add_u32 s94, s57, 2359296
    buffer_load_dwordx4 v[228:231], v20, s[16:19], s94 offen sc1
    s_add_u32 s94, s57, 2621440
    buffer_load_dwordx4 v[232:235], v19, s[16:19], s94 offen sc1
    v_smfmac_f32_16x16x64_bf16 v[96:99], v[92:95], v[84:91], v16
    v_exp_f32 v142, v142
    v_exp_f32 v143, v143
    v_exp_f32 v144, v144
    v_exp_f32 v145, v145
    v_exp_f32 v146, v146
    v_exp_f32 v147, v147
    v_cvt_pk_bf16_f32 v80, v140, v141
    v_cvt_pk_bf16_f32 v81, v142, v143
    v_cvt_pk_bf16_f32 v82, v144, v145
    v_cvt_pk_bf16_f32 v83, v146, v147
    s_waitcnt lgkmcnt(2)
    v_exp_f32 v116, v116
    v_exp_f32 v117, v117
    v_exp_f32 v118, v118
    v_exp_f32 v119, v119
    v_exp_f32 v120, v120
    v_exp_f32 v121, v121
    v_mfma_f32_32x32x16_bf16 v[100:115], v[60:63], v[76:79], v[100:115]
    v_exp_f32 v122, v122
    v_exp_f32 v123, v123
    v_cvt_pk_bf16_f32 v84, v116, v117
    v_cvt_pk_bf16_f32 v85, v118, v119
    v_mfma_f32_32x32x16_bf16 v[100:115], v[64:67], v[80:83], v[100:115]
    v_exp_f32 v124, v124
    v_exp_f32 v125, v125
    v_cvt_pk_bf16_f32 v86, v120, v121
    v_cvt_pk_bf16_f32 v87, v122, v123
    s_add_u32 s94, s57, 2621440
    buffer_load_dwordx4 v[236:239], v20, s[16:19], s94 offen sc1
    s_add_u32 s94, s57, 2883584
    buffer_load_dwordx4 v[240:243], v19, s[16:19], s94 offen sc1
    s_add_u32 s94, s57, 2883584
    buffer_load_dwordx4 v[244:247], v20, s[16:19], s94 offen sc1
    s_add_u32 m0, s40, 0
    s_add_u32 s93, s58, 65536
    buffer_load_dwordx4 v6, s[16:19], s93 offen offset:0 sc1 lds
    s_add_u32 m0, s40, 0
    s_add_u32 s93, s58, 65536
    buffer_load_dwordx4 v6, s[16:19], s93 offen offset:1024 sc1 lds
    s_add_u32 m0, s40, 0
    s_add_u32 s93, s58, 65536
    buffer_load_dwordx4 v6, s[16:19], s93 offen offset:2048 sc1 lds
    s_add_u32 m0, s40, 0
    s_add_u32 s93, s58, 65536
    buffer_load_dwordx4 v6, s[16:19], s93 offen offset:3072 sc1 lds
    v_smfmac_f32_16x16x64_bf16 v[96:99], v[92:95], v[76:83], v16
    v_exp_f32 v126, v126
    v_exp_f32 v127, v127
    v_exp_f32 v128, v128
    v_exp_f32 v129, v129
    v_exp_f32 v130, v130
    v_exp_f32 v131, v131
    v_cvt_pk_bf16_f32 v88, v124, v125
    v_cvt_pk_bf16_f32 v89, v126, v127
    v_cvt_pk_bf16_f32 v90, v128, v129
    v_cvt_pk_bf16_f32 v91, v130, v131
    s_waitcnt lgkmcnt(0)
    s_nop 1
    v_mfma_f32_32x32x16_bf16 v[100:115], v[68:71], v[84:87], v[100:115]
    v_mfma_f32_32x32x16_bf16 v[100:115], v[72:75], v[88:91], v[100:115]
    v_smfmac_f32_16x16x64_bf16 v[96:99], v[92:95], v[84:91], v16
    s_nop 15
    s_nop 3
    v_add_f32 v96, v96, v97
    v_maximum3_f32 v4, abs(v100), abs(v101), abs(v96)
    v_maximum3_f32 v4, abs(v102), abs(v103), v4
    v_maximum3_f32 v4, abs(v104), abs(v105), v4
    v_maximum3_f32 v4, abs(v106), abs(v107), v4
    v_maximum3_f32 v4, abs(v108), abs(v109), v4
    v_maximum3_f32 v4, abs(v110), abs(v111), v4
    v_maximum3_f32 v4, abs(v112), abs(v113), v4
    v_maximum3_f32 v4, abs(v114), abs(v115), v4
    s_mov_b32 s93, 0x7f000000
    s_mov_b32 s94, 0x21800000
    v_cmp_gt_f32 vcc, s93, v4
    v_cmp_le_f32 s[60:61], s94, v96
    s_mov_b32 s93, 0x5d800000
    v_cmp_ge_f32 s[62:63], s93, v96
    s_nop 3
    s_and_b64 vcc, vcc, s[60:61]
    s_and_b64 vcc, vcc, s[62:63]
    s_cmp_eq_u64 vcc, exec
    s_cbranch_scc0 L_fbB
L_stB:
    v_rcp_f32 v4, v96
    s_nop 0
    v_mul_f32 v4, v14, v4
    v_mov_b32 v5, v4
    v_pk_mul_f32 v[100:101], v[100:101], v[4:5]
    v_pk_mul_f32 v[102:103], v[102:103], v[4:5]
    v_pk_mul_f32 v[104:105], v[104:105], v[4:5]
    v_pk_mul_f32 v[106:107], v[106:107], v[4:5]
    v_pk_mul_f32 v[108:109], v[108:109], v[4:5]
    v_pk_mul_f32 v[110:111], v[110:111], v[4:5]
    v_pk_mul_f32 v[112:113], v[112:113], v[4:5]
    v_pk_mul_f32 v[114:115], v[114:115], v[4:5]
    v_cvt_pk_bf16_f32 v132, v100, v101
    v_cvt_pk_bf16_f32 v133, v102, v103
    v_cvt_pk_bf16_f32 v134, v104, v105
    v_cvt_pk_bf16_f32 v135, v106, v107
    v_cvt_pk_bf16_f32 v136, v108, v109
    v_cvt_pk_bf16_f32 v137, v110, v111
    v_cvt_pk_bf16_f32 v138, v112, v113
    v_cvt_pk_bf16_f32 v139, v114, v115
    buffer_store_dwordx4 v[132:135], v9, s[16:19], s45 offen sc1
    buffer_store_dwordx4 v[136:139], v9, s[16:19], s45 offen offset:512 sc1
    s_setprio 0
    ds_read_b128 v[36:39], v22 offset:0
    ds_read_b128 v[40:43], v22 offset:1024
    ds_read_b128 v[44:47], v22 offset:2048
    ds_read_b128 v[48:51], v22 offset:3072
    ds_read_b128 v[52:55], v22 offset:8192
    ds_read_b128 v[56:59], v22 offset:9216
    ds_read_b128 v[60:63], v22 offset:10240
    ds_read_b128 v[64:67], v22 offset:11264
    s_waitcnt vmcnt(28) lgkmcnt(4)
    s_setprio 1
    v_mfma_f32_16x16x32_bf16 v[84:87], v[36:39], v[148:151], 0
    ds_read_b128 v[68:71], v22 offset:16384
    v_mfma_f32_16x16x32_bf16 v[88:91], v[36:39], v[152:155], 0
    ds_read_b128 v[72:75], v22 offset:17408
    v_mfma_f32_16x16x32_bf16 v[92:95], v[40:43], v[148:151], 0
    ds_read_b128 v[76:79], v22 offset:18432
    v_mfma_f32_16x16x32_bf16 v[96:99], v[40:43], v[152:155], 0
    ds_read_b128 v[80:83], v22 offset:19456
    v_mfma_f32_16x16x32_bf16 v[100:103], v[44:47], v[148:151], 0
    v_mfma_f32_16x16x32_bf16 v[104:107], v[44:47], v[152:155], 0
    v_mfma_f32_16x16x32_bf16 v[108:111], v[48:51], v[148:151], 0
    v_mfma_f32_16x16x32_bf16 v[112:115], v[48:51], v[152:155], 0
    s_waitcnt vmcnt(26) lgkmcnt(4)
    s_setprio 0
    v_mfma_f32_16x16x32_bf16 v[84:87], v[52:55], v[156:159], v[84:87]
    ds_read_b128 v[36:39], v22 offset:24576
    v_mfma_f32_16x16x32_bf16 v[88:91], v[52:55], v[160:163], v[88:91]
    ds_read_b128 v[40:43], v22 offset:25600
    s_add_u32 s94, s57, 3145728
    buffer_load_dwordx4 v[148:151], v19, s[16:19], s94 offen sc1
    v_mfma_f32_16x16x32_bf16 v[92:95], v[56:59], v[156:159], v[92:95]
    ds_read_b128 v[44:47], v22 offset:26624
    s_add_u32 s94, s57, 3145728
    buffer_load_dwordx4 v[152:155], v20, s[16:19], s94 offen sc1
    v_mfma_f32_16x16x32_bf16 v[96:99], v[56:59], v[160:163], v[96:99]
    ds_read_b128 v[48:51], v22 offset:27648
    v_mfma_f32_16x16x32_bf16 v[100:103], v[60:63], v[156:159], v[100:103]
    v_mfma_f32_16x16x32_bf16 v[104:107], v[60:63], v[160:163], v[104:107]
    v_mfma_f32_16x16x32_bf16 v[108:111], v[64:67], v[156:159], v[108:111]
    v_mfma_f32_16x16x32_bf16 v[112:115], v[64:67], v[160:163], v[112:115]
    s_waitcnt vmcnt(2) lgkmcnt(0)
    s_barrier
    s_setprio 3
    s_cmp_eq_u32 s3, 0
    s_cbranch_scc0 L_sig0
    s_mov_b64 exec, 1
    buffer_atomic_add v18, v17, s[16:19], s59 offen offset:0 sc1
    s_mov_b64 exec, -1
L_sig0:
    v_mfma_f32_16x16x32_bf16 v[84:87], v[68:71], v[164:167], v[84:87]
    ds_read_b128 v[52:55], v22 offset:32768
    v_mfma_f32_16x16x32_bf16 v[88:91], v[68:71], v[168:171], v[88:91]
    ds_read_b128 v[56:59], v22 offset:33792
    s_add_u32 m0, s40, 32768
    s_add_u32 s93, s58, 98304
    buffer_load_dwordx4 v6, s[16:19], s93 offen offset:0 sc1 lds
    v_mfma_f32_16x16x32_bf16 v[92:95], v[72:75], v[164:167], v[92:95]
    ds_read_b128 v[60:63], v22 offset:34816
    s_add_u32 m0, s40, 32768
    s_add_u32 s93, s58, 98304
    buffer_load_dwordx4 v6, s[16:19], s93 offen offset:1024 sc1 lds
    v_mfma_f32_16x16x32_bf16 v[96:99], v[72:75], v[168:171], v[96:99]
    ds_read_b128 v[64:67], v22 offset:35840
    v_mfma_f32_16x16x32_bf16 v[100:103], v[76:79], v[164:167], v[100:103]
    v_mfma_f32_16x16x32_bf16 v[104:107], v[76:79], v[168:171], v[104:107]
    v_mfma_f32_16x16x32_bf16 v[108:111], v[80:83], v[164:167], v[108:111]
    v_mfma_f32_16x16x32_bf16 v[112:115], v[80:83], v[168:171], v[112:115]
    s_waitcnt vmcnt(26) lgkmcnt(4)
    s_setprio 2
    v_mfma_f32_16x16x32_bf16 v[84:87], v[36:39], v[172:175], v[84:87]
    ds_read_b128 v[68:71], v22 offset:40960
    v_mfma_f32_16x16x32_bf16 v[88:91], v[36:39], v[176:179], v[88:91]
    ds_read_b128 v[72:75], v22 offset:41984
    s_add_u32 m0, s40, 32768
    s_add_u32 s93, s58, 98304
    buffer_load_dwordx4 v6, s[16:19], s93 offen offset:2048 sc1 lds
    v_mfma_f32_16x16x32_bf16 v[92:95], v[40:43], v[172:175], v[92:95]
    ds_read_b128 v[76:79], v22 offset:43008
    s_add_u32 m0, s40, 32768
    s_add_u32 s93, s58, 98304
    buffer_load_dwordx4 v6, s[16:19], s93 offen offset:3072 sc1 lds
    v_mfma_f32_16x16x32_bf16 v[96:99], v[40:43], v[176:179], v[96:99]
    ds_read_b128 v[80:83], v22 offset:44032
    s_add_u32 s94, s57, 3407872
    buffer_load_dwordx4 v[156:159], v19, s[16:19], s94 offen sc1
    v_mfma_f32_16x16x32_bf16 v[100:103], v[44:47], v[172:175], v[100:103]
    v_mfma_f32_16x16x32_bf16 v[104:107], v[44:47], v[176:179], v[104:107]
    v_mfma_f32_16x16x32_bf16 v[108:111], v[48:51], v[172:175], v[108:111]
    v_mfma_f32_16x16x32_bf16 v[112:115], v[48:51], v[176:179], v[112:115]
    s_waitcnt vmcnt(27) lgkmcnt(4)
    s_setprio 1
    v_mfma_f32_16x16x32_bf16 v[84:87], v[52:55], v[180:183], v[84:87]
    ds_read_b128 v[36:39], v22 offset:49152
    v_mfma_f32_16x16x32_bf16 v[88:91], v[52:55], v[184:187], v[88:91]
    ds_read_b128 v[40:43], v22 offset:50176
    s_add_u32 s94, s57, 3407872
    buffer_load_dwordx4 v[160:163], v20, s[16:19], s94 offen sc1
    v_mfma_f32_16x16x32_bf16 v[92:95], v[56:59], v[180:183], v[92:95]
    ds_read_b128 v[44:47], v22 offset:51200
    s_add_u32 m0, s40, 65536
    s_add_u32 s93, s58, 2097152
    buffer_load_dwordx4 v6, s[16:19], s93 offen offset:0 sc1 lds
    v_mfma_f32_16x16x32_bf16 v[96:99], v[56:59], v[184:187], v[96:99]
    ds_read_b128 v[48:51], v22 offset:52224
    v_mfma_f32_16x16x32_bf16 v[100:103], v[60:63], v[180:183], v[100:103]
    v_mfma_f32_16x16x32_bf16 v[104:107], v[60:63], v[184:187], v[104:107]
    v_mfma_f32_16x16x32_bf16 v[108:111], v[64:67], v[180:183], v[108:111]
    v_mfma_f32_16x16x32_bf16 v[112:115], v[64:67], v[184:187], v[112:115]
    s_waitcnt vmcnt(27) lgkmcnt(4)
    s_setprio 0
    v_mfma_f32_16x16x32_bf16 v[84:87], v[68:71], v[188:191], v[84:87]
    ds_read_b128 v[52:55], v22 offset:57344
    v_mfma_f32_16x16x32_bf16 v[88:91], v[68:71], v[192:195], v[88:91]
    ds_read_b128 v[56:59], v22 offset:58368
    s_add_u32 m0, s40, 65536
    s_add_u32 s93, s58, 2097152
    buffer_load_dwordx4 v6, s[16:19], s93 offen offset:1024 sc1 lds
    v_mfma_f32_16x16x32_bf16 v[92:95], v[72:75], v[188:191], v[92:95]
    ds_read_b128 v[60:63], v22 offset:59392
    s_add_u32 m0, s40, 65536
    s_add_u32 s93, s58, 2097152
    buffer_load_dwordx4 v6, s[16:19], s93 offen offset:2048 sc1 lds
    v_mfma_f32_16x16x32_bf16 v[96:99], v[72:75], v[192:195], v[96:99]
    ds_read_b128 v[64:67], v22 offset:60416
    v_mfma_f32_16x16x32_bf16 v[100:103], v[76:79], v[188:191], v[100:103]
    v_mfma_f32_16x16x32_bf16 v[104:107], v[76:79], v[192:195], v[104:107]
    v_mfma_f32_16x16x32_bf16 v[108:111], v[80:83], v[188:191], v[108:111]
    v_mfma_f32_16x16x32_bf16 v[112:115], v[80:83], v[192:195], v[112:115]
    s_waitcnt vmcnt(13) lgkmcnt(0)
    s_barrier
    s_setprio 3
    v_mfma_f32_16x16x32_bf16 v[84:87], v[36:39], v[200:203], v[84:87]
    ds_read_b128 v[68:71], v21 offset:0
    v_mfma_f32_16x16x32_bf16 v[88:91], v[36:39], v[204:207], v[88:91]
    ds_read_b128 v[72:75], v21 offset:1024
    s_add_u32 m0, s40, 65536
    s_add_u32 s93, s58, 2097152
    buffer_load_dwordx4 v6, s[16:19], s93 offen offset:3072 sc1 lds
    v_mfma_f32_16x16x32_bf16 v[92:95], v[40:43], v[200:203], v[92:95]
    ds_read_b128 v[76:79], v21 offset:2048
    s_add_u32 s94, s57, 3670016
    buffer_load_dwordx4 v[164:167], v19, s[16:19], s94 offen sc1
    v_mfma_f32_16x16x32_bf16 v[96:99], v[40:43], v[204:207], v[96:99]
    ds_read_b128 v[80:83], v21 offset:3072
    s_add_u32 s94, s57, 3670016
    buffer_load_dwordx4 v[168:171], v20, s[16:19], s94 offen sc1
    v_mfma_f32_16x16x32_bf16 v[100:103], v[44:47], v[200:203], v[100:103]
    v_mfma_f32_16x16x32_bf16 v[104:107], v[44:47], v[204:207], v[104:107]
    v_mfma_f32_16x16x32_bf16 v[108:111], v[48:51], v[200:203], v[108:111]
    v_mfma_f32_16x16x32_bf16 v[112:115], v[48:51], v[204:207], v[112:115]
    s_waitcnt vmcnt(28) lgkmcnt(4)
    s_setprio 2
    buffer_load_dword v32, v17, s[16:19], s28 offen offset:0 sc1
    v_mfma_f32_16x16x32_bf16 v[84:87], v[52:55], v[208:211], v[84:87]
    ds_read_b128 v[36:39], v21 offset:8192
    v_mfma_f32_16x16x32_bf16 v[88:91], v[52:55], v[212:215], v[88:91]
    ds_read_b128 v[40:43], v21 offset:9216
    s_add_u32 s94, s57, 3932160
    buffer_load_dwordx4 v[172:175], v19, s[16:19], s94 offen sc1
    v_mfma_f32_16x16x32_bf16 v[92:95], v[56:59], v[208:211], v[92:95]
    ds_read_b128 v[44:47], v21 offset:10240
    s_add_u32 s94, s57, 3932160
    buffer_load_dwordx4 v[176:179], v20, s[16:19], s94 offen sc1
    v_mfma_f32_16x16x32_bf16 v[96:99], v[56:59], v[212:215], v[96:99]
    ds_read_b128 v[48:51], v21 offset:11264
    v_mfma_f32_16x16x32_bf16 v[100:103], v[60:63], v[208:211], v[100:103]
    v_mfma_f32_16x16x32_bf16 v[104:107], v[60:63], v[212:215], v[104:107]
    v_mfma_f32_16x16x32_bf16 v[108:111], v[64:67], v[208:211], v[108:111]
    v_mfma_f32_16x16x32_bf16 v[112:115], v[64:67], v[212:215], v[112:115]
    s_waitcnt vmcnt(29) lgkmcnt(4)
    s_setprio 1
    v_mfma_f32_16x16x32_bf16 v[84:87], v[68:71], v[216:219], v[84:87]
    ds_read_b128 v[52:55], v21 offset:16384
    v_mfma_f32_16x16x32_bf16 v[88:91], v[68:71], v[220:223], v[88:91]
    ds_read_b128 v[56:59], v21 offset:17408
    s_add_u32 m0, s40, 98304
    s_add_u32 s93, s58, 2129920
    buffer_load_dwordx4 v6, s[16:19], s93 offen offset:0 sc1 lds
    v_mfma_f32_16x16x32_bf16 v[92:95], v[72:75], v[216:219], v[92:95]
    ds_read_b128 v[60:63], v21 offset:18432
    s_add_u32 m0, s40, 98304
    s_add_u32 s93, s58, 2129920
    buffer_load_dwordx4 v6, s[16:19], s93 offen offset:1024 sc1 lds
    v_mfma_f32_16x16x32_bf16 v[96:99], v[72:75], v[220:223], v[96:99]
    ds_read_b128 v[64:67], v21 offset:19456
    v_mfma_f32_16x16x32_bf16 v[100:103], v[76:79], v[216:219], v[100:103]
    v_mfma_f32_16x16x32_bf16 v[104:107], v[76:79], v[220:223], v[104:107]
    v_mfma_f32_16x16x32_bf16 v[108:111], v[80:83], v[216:219], v[108:111]
    v_mfma_f32_16x16x32_bf16 v[112:115], v[80:83], v[220:223], v[112:115]
    s_waitcnt vmcnt(29) lgkmcnt(4)
    s_setprio 0
    v_mfma_f32_16x16x32_bf16 v[84:87], v[36:39], v[224:227], v[84:87]
    ds_read_b128 v[68:71], v21 offset:24576
    v_mfma_f32_16x16x32_bf16 v[88:91], v[36:39], v[228:231], v[88:91]
    ds_read_b128 v[72:75], v21 offset:25600
    s_waitcnt vmcnt(4)
    v_readfirstlane_b32 s93, v32
    s_cmp_ge_u32 s93, 32
    s_cbranch_scc0 L_spin0
L_go0:
    s_add_u32 s94, s57, 4194304
    buffer_load_dwordx4 v[180:183], v19, s[16:19], s94 offen sc1
    v_mfma_f32_16x16x32_bf16 v[92:95], v[40:43], v[224:227], v[92:95]
    ds_read_b128 v[76:79], v21 offset:26624
    s_add_u32 s94, s57, 4194304
    buffer_load_dwordx4 v[184:187], v20, s[16:19], s94 offen sc1
    v_mfma_f32_16x16x32_bf16 v[96:99], v[40:43], v[228:231], v[96:99]
    ds_read_b128 v[80:83], v21 offset:27648
    s_add_u32 s94, s57, 4456448
    buffer_load_dwordx4 v[188:191], v19, s[16:19], s94 offen sc1
    v_mfma_f32_16x16x32_bf16 v[100:103], v[44:47], v[224:227], v[100:103]
    v_mfma_f32_16x16x32_bf16 v[104:107], v[44:47], v[228:231], v[104:107]
    v_mfma_f32_16x16x32_bf16 v[108:111], v[48:51], v[224:227], v[108:111]
    v_mfma_f32_16x16x32_bf16 v[112:115], v[48:51], v[228:231], v[112:115]
    s_waitcnt vmcnt(16) lgkmcnt(0)
    s_barrier
    s_setprio 3
    v_mfma_f32_16x16x32_bf16 v[84:87], v[52:55], v[232:235], v[84:87]
    ds_read_b128 v[36:39], v21 offset:32768
    v_mfma_f32_16x16x32_bf16 v[88:91], v[52:55], v[236:239], v[88:91]
    ds_read_b128 v[40:43], v21 offset:33792
    s_add_u32 s94, s57, 4456448
    buffer_load_dwordx4 v[192:195], v20, s[16:19], s94 offen sc1
    v_mfma_f32_16x16x32_bf16 v[92:95], v[56:59], v[232:235], v[92:95]
    ds_read_b128 v[44:47], v21 offset:34816
    s_add_u32 m0, s40, 98304
    s_add_u32 s93, s58, 2129920
    buffer_load_dwordx4 v6, s[16:19], s93 offen offset:2048 sc1 lds
    v_mfma_f32_16x16x32_bf16 v[96:99], v[56:59], v[236:239], v[96:99]
    ds_read_b128 v[48:51], v21 offset:35840
    v_mfma_f32_16x16x32_bf16 v[100:103], v[60:63], v[232:235], v[100:103]
    v_mfma_f32_16x16x32_bf16 v[104:107], v[60:63], v[236:239], v[104:107]
    v_mfma_f32_16x16x32_bf16 v[108:111], v[64:67], v[232:235], v[108:111]
    v_mfma_f32_16x16x32_bf16 v[112:115], v[64:67], v[236:239], v[112:115]
    s_waitcnt vmcnt(30) lgkmcnt(4)
    s_setprio 2
    v_mfma_f32_16x16x32_bf16 v[84:87], v[68:71], v[240:243], v[84:87]
    ds_read_b128 v[52:55], v21 offset:40960
    v_mfma_f32_16x16x32_bf16 v[88:91], v[68:71], v[244:247], v[88:91]
    ds_read_b128 v[56:59], v21 offset:41984
    s_add_u32 m0, s40, 98304
    s_add_u32 s93, s58, 2129920
    buffer_load_dwordx4 v6, s[16:19], s93 offen offset:3072 sc1 lds
    v_mfma_f32_16x16x32_bf16 v[92:95], v[72:75], v[240:243], v[92:95]
    ds_read_b128 v[60:63], v21 offset:43008
    s_add_u32 s94, s57, 4718592
    buffer_load_dwordx4 v[200:203], v19, s[16:19], s94 offen sc1
    v_mfma_f32_16x16x32_bf16 v[96:99], v[72:75], v[244:247], v[96:99]
    ds_read_b128 v[64:67], v21 offset:44032
    v_mfma_f32_16x16x32_bf16 v[100:103], v[76:79], v[240:243], v[100:103]
    v_mfma_f32_16x16x32_bf16 v[104:107], v[76:79], v[244:247], v[104:107]
    v_mfma_f32_16x16x32_bf16 v[108:111], v[80:83], v[240:243], v[108:111]
    v_mfma_f32_16x16x32_bf16 v[112:115], v[80:83], v[244:247], v[112:115]
    s_waitcnt vmcnt(24) lgkmcnt(4)
    s_setprio 1
    v_mfma_f32_16x16x32_bf16 v[84:87], v[36:39], v[148:151], v[84:87]
    ds_read_b128 v[68:71], v21 offset:49152
    v_mfma_f32_16x16x32_bf16 v[88:91], v[36:39], v[152:155], v[88:91]
    ds_read_b128 v[72:75], v21 offset:50176
    s_add_u32 s94, s57, 4718592
    buffer_load_dwordx4 v[204:207], v20, s[16:19], s94 offen sc1
    v_mfma_f32_16x16x32_bf16 v[92:95], v[40:43], v[148:151], v[92:95]
    ds_read_b128 v[76:79], v21 offset:51200
    s_add_u32 s94, s57, 4980736
    buffer_load_dwordx4 v[208:211], v19, s[16:19], s94 offen sc1
    v_mfma_f32_16x16x32_bf16 v[96:99], v[40:43], v[152:155], v[96:99]
    ds_read_b128 v[80:83], v21 offset:52224
    v_mfma_f32_16x16x32_bf16 v[100:103], v[44:47], v[148:151], v[100:103]
    v_mfma_f32_16x16x32_bf16 v[104:107], v[44:47], v[152:155], v[104:107]
    v_mfma_f32_16x16x32_bf16 v[108:111], v[48:51], v[148:151], v[108:111]
    v_mfma_f32_16x16x32_bf16 v[112:115], v[48:51], v[152:155], v[112:115]
    s_waitcnt vmcnt(20) lgkmcnt(4)
    s_setprio 0
    v_mfma_f32_16x16x32_bf16 v[84:87], v[52:55], v[156:159], v[84:87]
    ds_read_b128 v[36:39], v21 offset:57344
    v_mfma_f32_16x16x32_bf16 v[88:91], v[52:55], v[160:163], v[88:91]
    ds_read_b128 v[40:43], v21 offset:58368
    s_add_u32 s94, s57, 4980736
    buffer_load_dwordx4 v[212:215], v20, s[16:19], s94 offen sc1
    v_mfma_f32_16x16x32_bf16 v[92:95], v[56:59], v[156:159], v[92:95]
    ds_read_b128 v[44:47], v21 offset:59392
    s_add_u32 s94, s57, 5242880
    buffer_load_dwordx4 v[216:219], v19, s[16:19], s94 offen sc1
    v_mfma_f32_16x16x32_bf16 v[96:99], v[56:59], v[160:163], v[96:99]
    ds_read_b128 v[48:51], v21 offset:60416
    s_add_u32 s94, s57, 5242880
    buffer_load_dwordx4 v[220:223], v20, s[16:19], s94 offen sc1
    v_mfma_f32_16x16x32_bf16 v[100:103], v[60:63], v[156:159], v[100:103]
    v_mfma_f32_16x16x32_bf16 v[104:107], v[60:63], v[160:163], v[104:107]
    v_mfma_f32_16x16x32_bf16 v[108:111], v[64:67], v[156:159], v[108:111]
    v_mfma_f32_16x16x32_bf16 v[112:115], v[64:67], v[160:163], v[112:115]
    s_waitcnt vmcnt(17) lgkmcnt(0)
    s_barrier
    s_setprio 3
    v_mfma_f32_16x16x32_bf16 v[84:87], v[68:71], v[164:167], v[84:87]
    ds_read_b128 v[52:55], v22 offset:0
    v_mfma_f32_16x16x32_bf16 v[88:91], v[68:71], v[168:171], v[88:91]
    ds_read_b128 v[56:59], v22 offset:1024
    s_add_u32 s94, s57, 5505024
    buffer_load_dwordx4 v[224:227], v19, s[16:19], s94 offen sc1
    v_mfma_f32_16x16x32_bf16 v[92:95], v[72:75], v[164:167], v[92:95]
    ds_read_b128 v[60:63], v22 offset:2048
    s_add_u32 s94, s57, 5505024
    buffer_load_dwordx4 v[228:231], v20, s[16:19], s94 offen sc1
    v_mfma_f32_16x16x32_bf16 v[96:99], v[72:75], v[168:171], v[96:99]
    ds_read_b128 v[64:67], v22 offset:3072
    v_mfma_f32_16x16x32_bf16 v[100:103], v[76:79], v[164:167], v[100:103]
    v_mfma_f32_16x16x32_bf16 v[104:107], v[76:79], v[168:171], v[104:107]
    v_mfma_f32_16x16x32_bf16 v[108:111], v[80:83], v[164:167], v[108:111]
    v_mfma_f32_16x16x32_bf16 v[112:115], v[80:83], v[168:171], v[112:115]
    s_waitcnt vmcnt(16) lgkmcnt(4)
    s_setprio 2
    v_mfma_f32_16x16x32_bf16 v[84:87], v[36:39], v[172:175], v[84:87]
    ds_read_b128 v[68:71], v22 offset:8192
    v_mfma_f32_16x16x32_bf16 v[88:91], v[36:39], v[176:179], v[88:91]
    ds_read_b128 v[72:75], v22 offset:9216
    s_add_u32 m0, s40, 0
    s_add_u32 s93, s58, 2162688
    buffer_load_dwordx4 v6, s[16:19], s93 offen offset:0 sc1 lds
    v_mfma_f32_16x16x32_bf16 v[92:95], v[40:43], v[172:175], v[92:95]
    ds_read_b128 v[76:79], v22 offset:10240
    s_add_u32 m0, s40, 0
    s_add_u32 s93, s58, 2162688
    buffer_load_dwordx4 v6, s[16:19], s93 offen offset:1024 sc1 lds
    v_mfma_f32_16x16x32_bf16 v[96:99], v[40:43], v[176:179], v[96:99]
    ds_read_b128 v[80:83], v22 offset:11264
    v_mfma_f32_16x16x32_bf16 v[100:103], v[44:47], v[172:175], v[100:103]
    v_mfma_f32_16x16x32_bf16 v[104:107], v[44:47], v[176:179], v[104:107]
    v_mfma_f32_16x16x32_bf16 v[108:111], v[48:51], v[172:175], v[108:111]
    v_mfma_f32_16x16x32_bf16 v[112:115], v[48:51], v[176:179], v[112:115]
    s_waitcnt vmcnt(14) lgkmcnt(4)
    s_setprio 1
    v_mfma_f32_16x16x32_bf16 v[84:87], v[52:55], v[180:183], v[84:87]
    ds_read_b128 v[36:39], v22 offset:16384
    v_mfma_f32_16x16x32_bf16 v[88:91], v[52:55], v[184:187], v[88:91]
    ds_read_b128 v[40:43], v22 offset:17408
    s_add_u32 m0, s40, 0
    s_add_u32 s93, s58, 2162688
    buffer_load_dwordx4 v6, s[16:19], s93 offen offset:2048 sc1 lds
    v_mfma_f32_16x16x32_bf16 v[92:95], v[56:59], v[180:183], v[92:95]
    ds_read_b128 v[44:47], v22 offset:18432
    s_add_u32 m0, s40, 0
    s_add_u32 s93, s58, 2162688
    buffer_load_dwordx4 v6, s[16:19], s93 offen offset:3072 sc1 lds
    v_mfma_f32_16x16x32_bf16 v[96:99], v[56:59], v[184:187], v[96:99]
    ds_read_b128 v[48:51], v22 offset:19456
    s_add_u32 s94, s57, 5767168
    buffer_load_dwordx4 v[232:235], v19, s[16:19], s94 offen sc1
    v_mfma_f32_16x16x32_bf16 v[100:103], v[60:63], v[180:183], v[100:103]
    v_mfma_f32_16x16x32_bf16 v[104:107], v[60:63], v[184:187], v[104:107]
    v_mfma_f32_16x16x32_bf16 v[108:111], v[64:67], v[180:183], v[108:111]
    v_mfma_f32_16x16x32_bf16 v[112:115], v[64:67], v[184:187], v[112:115]
    s_waitcnt vmcnt(15) lgkmcnt(4)
    s_setprio 0
    v_mfma_f32_16x16x32_bf16 v[84:87], v[68:71], v[188:191], v[84:87]
    ds_read_b128 v[52:55], v22 offset:24576
    v_mfma_f32_16x16x32_bf16 v[88:91], v[68:71], v[192:195], v[88:91]
    ds_read_b128 v[56:59], v22 offset:25600
    s_add_u32 s94, s57, 5767168
    buffer_load_dwordx4 v[236:239], v20, s[16:19], s94 offen sc1
    v_mfma_f32_16x16x32_bf16 v[92:95], v[72:75], v[188:191], v[92:95]
    ds_read_b128 v[60:63], v22 offset:26624
    s_add_u32 s94, s57, 6029312
    buffer_load_dwordx4 v[240:243], v19, s[16:19], s94 offen sc1
    v_mfma_f32_16x16x32_bf16 v[96:99], v[72:75], v[192:195], v[96:99]
    ds_read_b128 v[64:67], v22 offset:27648
    v_mfma_f32_16x16x32_bf16 v[100:103], v[76:79], v[188:191], v[100:103]
    v_mfma_f32_16x16x32_bf16 v[104:107], v[76:79], v[192:195], v[104:107]
    v_mfma_f32_16x16x32_bf16 v[108:111], v[80:83], v[188:191], v[108:111]
    v_mfma_f32_16x16x32_bf16 v[112:115], v[80:83], v[192:195], v[112:115]
    s_waitcnt vmcnt(13) lgkmcnt(0)
    s_barrier
    s_setprio 3
    v_mfma_f32_16x16x32_bf16 v[84:87], v[36:39], v[200:203], v[84:87]
    ds_read_b128 v[68:71], v22 offset:32768
    v_mfma_f32_16x16x32_bf16 v[88:91], v[36:39], v[204:207], v[88:91]
    ds_read_b128 v[72:75], v22 offset:33792
    s_add_u32 s94, s57, 6029312
    buffer_load_dwordx4 v[244:247], v20, s[16:19], s94 offen sc1
    v_mfma_f32_16x16x32_bf16 v[92:95], v[40:43], v[200:203], v[92:95]
    ds_read_b128 v[76:79], v22 offset:34816
    s_add_u32 s94, s57, 6291456
    buffer_load_dwordx4 v[148:151], v19, s[16:19], s94 offen sc1
    v_mfma_f32_16x16x32_bf16 v[96:99], v[40:43], v[204:207], v[96:99]
    ds_read_b128 v[80:83], v22 offset:35840
    v_mfma_f32_16x16x32_bf16 v[100:103], v[44:47], v[200:203], v[100:103]
    v_mfma_f32_16x16x32_bf16 v[104:107], v[44:47], v[204:207], v[104:107]
    v_mfma_f32_16x16x32_bf16 v[108:111], v[48:51], v[200:203], v[108:111]
    v_mfma_f32_16x16x32_bf16 v[112:115], v[48:51], v[204:207], v[112:115]
    s_waitcnt vmcnt(13) lgkmcnt(4)
    s_setprio 2
    v_mfma_f32_16x16x32_bf16 v[84:87], v[52:55], v[208:211], v[84:87]
    ds_read_b128 v[36:39], v22 offset:40960
    v_mfma_f32_16x16x32_bf16 v[88:91], v[52:55], v[212:215], v[88:91]
    ds_read_b128 v[40:43], v22 offset:41984
    s_add_u32 s94, s57, 6291456
    buffer_load_dwordx4 v[152:155], v20, s[16:19], s94 offen sc1
    v_mfma_f32_16x16x32_bf16 v[92:95], v[56:59], v[208:211], v[92:95]
    ds_read_b128 v[44:47], v22 offset:43008
    s_add_u32 s94, s57, 6553600
    buffer_load_dwordx4 v[156:159], v19, s[16:19], s94 offen sc1
    v_mfma_f32_16x16x32_bf16 v[96:99], v[56:59], v[212:215], v[96:99]
    ds_read_b128 v[48:51], v22 offset:44032
    s_add_u32 s94, s57, 6553600
    buffer_load_dwordx4 v[160:163], v20, s[16:19], s94 offen sc1
    v_mfma_f32_16x16x32_bf16 v[100:103], v[60:63], v[208:211], v[100:103]
    v_mfma_f32_16x16x32_bf16 v[104:107], v[60:63], v[212:215], v[104:107]
    v_mfma_f32_16x16x32_bf16 v[108:111], v[64:67], v[208:211], v[108:111]
    v_mfma_f32_16x16x32_bf16 v[112:115], v[64:67], v[212:215], v[112:115]
    s_waitcnt vmcnt(14) lgkmcnt(4)
    s_setprio 1
    v_mfma_f32_16x16x32_bf16 v[84:87], v[68:71], v[216:219], v[84:87]
    ds_read_b128 v[52:55], v22 offset:49152
    v_mfma_f32_16x16x32_bf16 v[88:91], v[68:71], v[220:223], v[88:91]
    ds_read_b128 v[56:59], v22 offset:50176
    s_add_u32 m0, s40, 32768
    s_add_u32 s93, s58, 2195456
    buffer_load_dwordx4 v6, s[16:19], s93 offen offset:0 sc1 lds
    v_mfma_f32_16x16x32_bf16 v[92:95], v[72:75], v[216:219], v[92:95]
    ds_read_b128 v[60:63], v22 offset:51200
    s_add_u32 m0, s40, 32768
    s_add_u32 s93, s58, 2195456
    buffer_load_dwordx4 v6, s[16:19], s93 offen offset:1024 sc1 lds
    v_mfma_f32_16x16x32_bf16 v[96:99], v[72:75], v[220:223], v[96:99]
    ds_read_b128 v[64:67], v22 offset:52224
    v_mfma_f32_16x16x32_bf16 v[100:103], v[76:79], v[216:219], v[100:103]
    v_mfma_f32_16x16x32_bf16 v[104:107], v[76:79], v[220:223], v[104:107]
    v_mfma_f32_16x16x32_bf16 v[108:111], v[80:83], v[216:219], v[108:111]
    v_mfma_f32_16x16x32_bf16 v[112:115], v[80:83], v[220:223], v[112:115]
    s_waitcnt vmcnt(14) lgkmcnt(4)
    s_setprio 0
    v_mfma_f32_16x16x32_bf16 v[84:87], v[36:39], v[224:227], v[84:87]
    ds_read_b128 v[68:71], v22 offset:57344
    v_mfma_f32_16x16x32_bf16 v[88:91], v[36:39], v[228:231], v[88:91]
    ds_read_b128 v[72:75], v22 offset:58368
    s_add_u32 m0, s40, 32768
    s_add_u32 s93, s58, 2195456
    buffer_load_dwordx4 v6, s[16:19], s93 offen offset:2048 sc1 lds
    v_mfma_f32_16x16x32_bf16 v[92:95], v[40:43], v[224:227], v[92:95]
    ds_read_b128 v[76:79], v22 offset:59392
    s_add_u32 m0, s40, 32768
    s_add_u32 s93, s58, 2195456
    buffer_load_dwordx4 v6, s[16:19], s93 offen offset:3072 sc1 lds
    v_mfma_f32_16x16x32_bf16 v[96:99], v[40:43], v[228:231], v[96:99]
    ds_read_b128 v[80:83], v22 offset:60416
    v_mfma_f32_16x16x32_bf16 v[100:103], v[44:47], v[224:227], v[100:103]
    v_mfma_f32_16x16x32_bf16 v[104:107], v[44:47], v[228:231], v[104:107]
    v_mfma_f32_16x16x32_bf16 v[108:111], v[48:51], v[224:227], v[108:111]
    v_mfma_f32_16x16x32_bf16 v[112:115], v[48:51], v[228:231], v[112:115]
    s_waitcnt vmcnt(10) lgkmcnt(0)
    s_barrier
    s_setprio 3
    v_mfma_f32_16x16x32_bf16 v[84:87], v[52:55], v[232:235], v[84:87]
    ds_read_b128 v[36:39], v21 offset:0
    v_mfma_f32_16x16x32_bf16 v[88:91], v[52:55], v[236:239], v[88:91]
    ds_read_b128 v[40:43], v21 offset:1024
    s_add_u32 s94, s57, 6815744
    buffer_load_dwordx4 v[164:167], v19, s[16:19], s94 offen sc1
    v_mfma_f32_16x16x32_bf16 v[92:95], v[56:59], v[232:235], v[92:95]
    ds_read_b128 v[44:47], v21 offset:2048
    s_add_u32 s94, s57, 6815744
    buffer_load_dwordx4 v[168:171], v20, s[16:19], s94 offen sc1
    v_mfma_f32_16x16x32_bf16 v[96:99], v[56:59], v[236:239], v[96:99]
    ds_read_b128 v[48:51], v21 offset:3072
    v_mfma_f32_16x16x32_bf16 v[100:103], v[60:63], v[232:235], v[100:103]
    v_mfma_f32_16x16x32_bf16 v[104:107], v[60:63], v[236:239], v[104:107]
    v_mfma_f32_16x16x32_bf16 v[108:111], v[64:67], v[232:235], v[108:111]
    v_mfma_f32_16x16x32_bf16 v[112:115], v[64:67], v[236:239], v[112:115]
    s_waitcnt vmcnt(10) lgkmcnt(4)
    s_setprio 2
    v_mfma_f32_16x16x32_bf16 v[84:87], v[68:71], v[240:243], v[84:87]
    ds_read_b128 v[52:55], v21 offset:8192
    v_mfma_f32_16x16x32_bf16 v[88:91], v[68:71], v[244:247], v[88:91]
    ds_read_b128 v[56:59], v21 offset:9216
    s_add_u32 s94, s57, 7077888
    buffer_load_dwordx4 v[172:175], v19, s[16:19], s94 offen sc1
    v_mfma_f32_16x16x32_bf16 v[92:95], v[72:75], v[240:243], v[92:95]
    ds_read_b128 v[60:63], v21 offset:10240
    s_add_u32 s94, s57, 7077888
    buffer_load_dwordx4 v[176:179], v20, s[16:19], s94 offen sc1
    v_mfma_f32_16x16x32_bf16 v[96:99], v[72:75], v[244:247], v[96:99]
    ds_read_b128 v[64:67], v21 offset:11264
    s_add_u32 s94, s57, 7340032
    buffer_load_dwordx4 v[180:183], v19, s[16:19], s94 offen sc1
    v_mfma_f32_16x16x32_bf16 v[100:103], v[76:79], v[240:243], v[100:103]
    v_mfma_f32_16x16x32_bf16 v[104:107], v[76:79], v[244:247], v[104:107]
    v_mfma_f32_16x16x32_bf16 v[108:111], v[80:83], v[240:243], v[108:111]
    v_mfma_f32_16x16x32_bf16 v[112:115], v[80:83], v[244:247], v[112:115]
    s_waitcnt vmcnt(11) lgkmcnt(4)
    s_setprio 1
    v_mfma_f32_16x16x32_bf16 v[84:87], v[36:39], v[148:151], v[84:87]
    ds_read_b128 v[68:71], v21 offset:16384
    v_mfma_f32_16x16x32_bf16 v[88:91], v[36:39], v[152:155], v[88:91]
    ds_read_b128 v[72:75], v21 offset:17408
    s_add_u32 s94, s57, 7340032
    buffer_load_dwordx4 v[184:187], v20, s[16:19], s94 offen sc1
    v_mfma_f32_16x16x32_bf16 v[92:95], v[40:43], v[148:151], v[92:95]
    ds_read_b128 v[76:79], v21 offset:18432
    s_add_u32 s94, s57, 7602176
    buffer_load_dwordx4 v[188:191], v19, s[16:19], s94 offen sc1
    v_mfma_f32_16x16x32_bf16 v[96:99], v[40:43], v[152:155], v[96:99]
    ds_read_b128 v[80:83], v21 offset:19456
    v_mfma_f32_16x16x32_bf16 v[100:103], v[44:47], v[148:151], v[100:103]
    v_mfma_f32_16x16x32_bf16 v[104:107], v[44:47], v[152:155], v[104:107]
    v_mfma_f32_16x16x32_bf16 v[108:111], v[48:51], v[148:151], v[108:111]
    v_mfma_f32_16x16x32_bf16 v[112:115], v[48:51], v[152:155], v[112:115]
    s_waitcnt vmcnt(11) lgkmcnt(4)
    s_setprio 0
    v_mfma_f32_16x16x32_bf16 v[84:87], v[52:55], v[156:159], v[84:87]
    ds_read_b128 v[36:39], v21 offset:24576
    v_mfma_f32_16x16x32_bf16 v[88:91], v[52:55], v[160:163], v[88:91]
    ds_read_b128 v[40:43], v21 offset:25600
    s_add_u32 s94, s57, 7602176
    buffer_load_dwordx4 v[192:195], v20, s[16:19], s94 offen sc1
    v_mfma_f32_16x16x32_bf16 v[92:95], v[56:59], v[156:159], v[92:95]
    ds_read_b128 v[44:47], v21 offset:26624
    s_add_u32 s94, s57, 7864320
    buffer_load_dwordx4 v[200:203], v19, s[16:19], s94 offen sc1
    v_mfma_f32_16x16x32_bf16 v[96:99], v[56:59], v[160:163], v[96:99]
    ds_read_b128 v[48:51], v21 offset:27648
    v_mfma_f32_16x16x32_bf16 v[100:103], v[60:63], v[156:159], v[100:103]
    v_mfma_f32_16x16x32_bf16 v[104:107], v[60:63], v[160:163], v[104:107]
    v_mfma_f32_16x16x32_bf16 v[108:111], v[64:67], v[156:159], v[108:111]
    v_mfma_f32_16x16x32_bf16 v[112:115], v[64:67], v[160:163], v[112:115]
    s_waitcnt vmcnt(7) lgkmcnt(0)
    s_barrier
    s_setprio 2
    v_mfma_f32_16x16x32_bf16 v[84:87], v[68:71], v[164:167], v[84:87]
    ds_read_b128 v[52:55], v21 offset:32768
    v_mfma_f32_16x16x32_bf16 v[88:91], v[68:71], v[168:171], v[88:91]
    ds_read_b128 v[56:59], v21 offset:33792
    s_add_u32 s94, s57, 7864320
    buffer_load_dwordx4 v[204:207], v20, s[16:19], s94 offen sc1
    v_mfma_f32_16x16x32_bf16 v[92:95], v[72:75], v[164:167], v[92:95]
    ds_read_b128 v[60:63], v21 offset:34816
    s_add_u32 s94, s57, 8126464
    buffer_load_dwordx4 v[208:211], v19, s[16:19], s94 offen sc1
    v_mfma_f32_16x16x32_bf16 v[96:99], v[72:75], v[168:171], v[96:99]
    ds_read_b128 v[64:67], v21 offset:35840
    s_add_u32 s94, s57, 8126464
    buffer_load_dwordx4 v[212:215], v20, s[16:19], s94 offen sc1
    v_mfma_f32_16x16x32_bf16 v[100:103], v[76:79], v[164:167], v[100:103]
    v_mfma_f32_16x16x32_bf16 v[104:107], v[76:79], v[168:171], v[104:107]
    v_mfma_f32_16x16x32_bf16 v[108:111], v[80:83], v[164:167], v[108:111]
    v_mfma_f32_16x16x32_bf16 v[112:115], v[80:83], v[168:171], v[112:115]
    s_waitcnt vmcnt(8) lgkmcnt(4)
    s_setprio 2
    v_mfma_f32_16x16x32_bf16 v[84:87], v[36:39], v[172:175], v[84:87]
    ds_read_b128 v[68:71], v21 offset:40960
    v_mfma_f32_16x16x32_bf16 v[88:91], v[36:39], v[176:179], v[88:91]
    ds_read_b128 v[72:75], v21 offset:41984
    v_mfma_f32_16x16x32_bf16 v[92:95], v[40:43], v[172:175], v[92:95]
    ds_read_b128 v[76:79], v21 offset:43008
    v_mfma_f32_16x16x32_bf16 v[96:99], v[40:43], v[176:179], v[96:99]
    ds_read_b128 v[80:83], v21 offset:44032
    v_mfma_f32_16x16x32_bf16 v[100:103], v[44:47], v[172:175], v[100:103]
    v_mfma_f32_16x16x32_bf16 v[104:107], v[44:47], v[176:179], v[104:107]
    v_mfma_f32_16x16x32_bf16 v[108:111], v[48:51], v[172:175], v[108:111]
    v_mfma_f32_16x16x32_bf16 v[112:115], v[48:51], v[176:179], v[112:115]
    s_waitcnt vmcnt(6) lgkmcnt(4)
    s_setprio 1
    v_mfma_f32_16x16x32_bf16 v[84:87], v[52:55], v[180:183], v[84:87]
    ds_read_b128 v[36:39], v21 offset:49152
    v_mfma_f32_16x16x32_bf16 v[88:91], v[52:55], v[184:187], v[88:91]
    ds_read_b128 v[40:43], v21 offset:50176
    v_mfma_f32_16x16x32_bf16 v[92:95], v[56:59], v[180:183], v[92:95]
    ds_read_b128 v[44:47], v21 offset:51200
    v_mfma_f32_16x16x32_bf16 v[96:99], v[56:59], v[184:187], v[96:99]
    ds_read_b128 v[48:51], v21 offset:52224
    v_mfma_f32_16x16x32_bf16 v[100:103], v[60:63], v[180:183], v[100:103]
    v_mfma_f32_16x16x32_bf16 v[104:107], v[60:63], v[184:187], v[104:107]
    v_mfma_f32_16x16x32_bf16 v[108:111], v[64:67], v[180:183], v[108:111]
    v_mfma_f32_16x16x32_bf16 v[112:115], v[64:67], v[184:187], v[112:115]
    s_waitcnt vmcnt(4) lgkmcnt(4)
    s_setprio 1
    v_mfma_f32_16x16x32_bf16 v[84:87], v[68:71], v[188:191], v[84:87]
    ds_read_b128 v[52:55], v21 offset:57344
    v_mfma_f32_16x16x32_bf16 v[88:91], v[68:71], v[192:195], v[88:91]
    ds_read_b128 v[56:59], v21 offset:58368
    v_mfma_f32_16x16x32_bf16 v[92:95], v[72:75], v[188:191], v[92:95]
    ds_read_b128 v[60:63], v21 offset:59392
    v_mfma_f32_16x16x32_bf16 v[96:99], v[72:75], v[192:195], v[96:99]
    ds_read_b128 v[64:67], v21 offset:60416
    v_mfma_f32_16x16x32_bf16 v[100:103], v[76:79], v[188:191], v[100:103]
    v_mfma_f32_16x16x32_bf16 v[104:107], v[76:79], v[192:195], v[104:107]
    v_mfma_f32_16x16x32_bf16 v[108:111], v[80:83], v[188:191], v[108:111]
    v_mfma_f32_16x16x32_bf16 v[112:115], v[80:83], v[192:195], v[112:115]
    s_waitcnt vmcnt(2) lgkmcnt(4)
    s_setprio 0
    v_mfma_f32_16x16x32_bf16 v[84:87], v[36:39], v[200:203], v[84:87]
    v_mfma_f32_16x16x32_bf16 v[88:91], v[36:39], v[204:207], v[88:91]
    v_mfma_f32_16x16x32_bf16 v[92:95], v[40:43], v[200:203], v[92:95]
    v_mfma_f32_16x16x32_bf16 v[96:99], v[40:43], v[204:207], v[96:99]
    v_mfma_f32_16x16x32_bf16 v[100:103], v[44:47], v[200:203], v[100:103]
    v_mfma_f32_16x16x32_bf16 v[104:107], v[44:47], v[204:207], v[104:107]
    v_mfma_f32_16x16x32_bf16 v[108:111], v[48:51], v[200:203], v[108:111]
    v_mfma_f32_16x16x32_bf16 v[112:115], v[48:51], v[204:207], v[112:115]
    s_waitcnt vmcnt(0) lgkmcnt(0)
    s_setprio 0
    v_mfma_f32_16x16x32_bf16 v[84:87], v[52:55], v[208:211], v[84:87]
    v_mfma_f32_16x16x32_bf16 v[88:91], v[52:55], v[212:215], v[88:91]
    v_mfma_f32_16x16x32_bf16 v[92:95], v[56:59], v[208:211], v[92:95]
    v_mfma_f32_16x16x32_bf16 v[96:99], v[56:59], v[212:215], v[96:99]
    v_mfma_f32_16x16x32_bf16 v[100:103], v[60:63], v[208:211], v[100:103]
    v_mfma_f32_16x16x32_bf16 v[104:107], v[60:63], v[212:215], v[104:107]
    v_mfma_f32_16x16x32_bf16 v[108:111], v[64:67], v[208:211], v[108:111]
    v_mfma_f32_16x16x32_bf16 v[112:115], v[64:67], v[212:215], v[112:115]
    s_nop 7
    ds_write_b128 v24, v[88:91] offset:0
    ds_write_b128 v24, v[96:99] offset:1024
    ds_write_b128 v24, v[104:107] offset:2048
    ds_write_b128 v24, v[112:115] offset:3072
    s_waitcnt lgkmcnt(0)
    s_barrier
    ds_read_b128 v[36:39], v25 offset:0
    ds_read_b128 v[40:43], v25 offset:1024
    ds_read_b128 v[44:47], v25 offset:2048
    ds_read_b128 v[48:51], v25 offset:3072
    s_waitcnt lgkmcnt(3)
    v_add_f32 v84, v84, v36
    v_add_f32 v85, v85, v37
    v_add_f32 v86, v86, v38
    v_add_f32 v87, v87, v39
    v_cvt_pk_bf16_f32 v52, v84, v85
    v_cvt_pk_bf16_f32 v53, v86, v87
    s_waitcnt lgkmcnt(2)
    v_add_f32 v92, v92, v40
    v_add_f32 v93, v93, v41
    v_add_f32 v94, v94, v42
    v_add_f32 v95, v95, v43
    v_cvt_pk_bf16_f32 v54, v92, v93
    v_cvt_pk_bf16_f32 v55, v94, v95
    s_nop 1
    v_permlane16_swap_b32 v52, v54
    v_permlane16_swap_b32 v53, v55
    s_nop 1
    buffer_store_dwordx4 v[52:55], v23, s[24:27], 0 offen offset:0 nt
    s_waitcnt lgkmcnt(1)
    v_add_f32 v100, v100, v44
    v_add_f32 v101, v101, v45
    v_add_f32 v102, v102, v46
    v_add_f32 v103, v103, v47
    v_cvt_pk_bf16_f32 v56, v100, v101
    v_cvt_pk_bf16_f32 v57, v102, v103
    s_waitcnt lgkmcnt(0)
    v_add_f32 v108, v108, v48
    v_add_f32 v109, v109, v49
    v_add_f32 v110, v110, v50
    v_add_f32 v111, v111, v51
    v_cvt_pk_bf16_f32 v58, v108, v109
    v_cvt_pk_bf16_f32 v59, v110, v111
    s_nop 1
    v_permlane16_swap_b32 v56, v58
    v_permlane16_swap_b32 v57, v59
    s_nop 1
    buffer_store_dwordx4 v[56:59], v23, s[24:27], 0 offen offset:64 nt
L_end:
    s_endpgm
L_sw1:
    v_mov_b32 v164, 0
    v_mov_b32 v165, 0
    v_mov_b32 v166, 0
    v_mov_b32 v167, 0
    v_mov_b32 v168, 0
    v_mov_b32 v169, 0
    v_mov_b32 v170, 0
    v_mov_b32 v171, 0
    v_mov_b32 v172, 0
    v_mov_b32 v173, 0
    v_mov_b32 v174, 0
    v_mov_b32 v175, 0
    v_mov_b32 v176, 0
    v_mov_b32 v177, 0
    v_mov_b32 v178, 0
    v_mov_b32 v179, 0
    s_nop 1
    s_branch L_sk1
L_sw2:
    v_mov_b32 v164, 0
    v_mov_b32 v165, 0
    v_mov_b32 v166, 0
    v_mov_b32 v167, 0
    v_mov_b32 v168, 0
    v_mov_b32 v169, 0
    v_mov_b32 v170, 0
    v_mov_b32 v171, 0
    v_mov_b32 v172, 0
    v_mov_b32 v173, 0
    v_mov_b32 v174, 0
    v_mov_b32 v175, 0
    v_mov_b32 v176, 0
    v_mov_b32 v177, 0
    v_mov_b32 v178, 0
    v_mov_b32 v179, 0
    s_nop 1
    s_branch L_sk2
L_sw3:
    v_mov_b32 v164, 0
    v_mov_b32 v165, 0
    v_mov_b32 v166, 0
    v_mov_b32 v167, 0
    v_mov_b32 v168, 0
    v_mov_b32 v169, 0
    v_mov_b32 v170, 0
    v_mov_b32 v171, 0
    v_mov_b32 v172, 0
    v_mov_b32 v173, 0
    v_mov_b32 v174, 0
    v_mov_b32 v175, 0
    v_mov_b32 v176, 0
    v_mov_b32 v177, 0
    v_mov_b32 v178, 0
    v_mov_b32 v179, 0
    s_nop 1
    s_branch L_sk3
L_sw4:
    v_mov_b32 v164, 0
    v_mov_b32 v165, 0
    v_mov_b32 v166, 0
    v_mov_b32 v167, 0
    v_mov_b32 v168, 0
    v_mov_b32 v169, 0
    v_mov_b32 v170, 0
    v_mov_b32 v171, 0
    v_mov_b32 v172, 0
    v_mov_b32 v173, 0
    v_mov_b32 v174, 0
    v_mov_b32 v175, 0
    v_mov_b32 v176, 0
    v_mov_b32 v177, 0
    v_mov_b32 v178, 0
    v_mov_b32 v179, 0
    s_nop 1
    s_branch L_sk4
L_sw5:
    v_mov_b32 v164, 0
    v_mov_b32 v165, 0
    v_mov_b32 v166, 0
    v_mov_b32 v167, 0
    v_mov_b32 v168, 0
    v_mov_b32 v169, 0
    v_mov_b32 v170, 0
    v_mov_b32 v171, 0
    v_mov_b32 v172, 0
    v_mov_b32 v173, 0
    v_mov_b32 v174, 0
    v_mov_b32 v175, 0
    v_mov_b32 v176, 0
    v_mov_b32 v177, 0
    v_mov_b32 v178, 0
    v_mov_b32 v179, 0
    s_nop 1
    s_branch L_sk5
L_sw6:
    v_mov_b32 v164, 0
    v_mov_b32 v165, 0
    v_mov_b32 v166, 0
    v_mov_b32 v167, 0
    v_mov_b32 v168, 0
    v_mov_b32 v169, 0
    v_mov_b32 v170, 0
    v_mov_b32 v171, 0
    v_mov_b32 v172, 0
    v_mov_b32 v173, 0
    v_mov_b32 v174, 0
    v_mov_b32 v175, 0
    v_mov_b32 v176, 0
    v_mov_b32 v177, 0
    v_mov_b32 v178, 0
    v_mov_b32 v179, 0
    s_nop 1
    s_branch L_sk6
L_sw7:
    v_mov_b32 v164, 0
    v_mov_b32 v165, 0
    v_mov_b32 v166, 0
    v_mov_b32 v167, 0
    v_mov_b32 v168, 0
    v_mov_b32 v169, 0
    v_mov_b32 v170, 0
    v_mov_b32 v171, 0
    v_mov_b32 v172, 0
    v_mov_b32 v173, 0
    v_mov_b32 v174, 0
    v_mov_b32 v175, 0
    v_mov_b32 v176, 0
    v_mov_b32 v177, 0
    v_mov_b32 v178, 0
    v_mov_b32 v179, 0
    s_nop 1
    s_branch L_sk7
L_pubini:
    v_mov_b32 v21, 1
    v_mov_b32 v2, 0
    s_mov_b64 exec, 1
    buffer_store_dword v21, v2, s[72:75], 0 offen sc1
    s_mov_b64 exec, -1
    s_branch L_pubini_b
L_spini:
    s_mov_b32 s95, 0
L_spini_l:
    s_sleep 6
    buffer_load_dword v21, v3, s[72:75], 0 offen sc1
    s_waitcnt vmcnt(0)
    v_readfirstlane_b32 s93, v21
    s_cmp_lg_u32 s93, 0
    s_cbranch_scc1 L_inigo
    s_add_u32 s95, s95, 1
    s_cmp_lt_u32 s95, 16384
    s_cbranch_scc1 L_spini_l
    s_branch L_inigo
L_spf1:
    s_mov_b32 s95, 0
L_spf1_l:
    s_sleep 6
    buffer_load_dword v32, v253, s[16:19], 0 offen sc1
    s_waitcnt vmcnt(0)
    v_cmp_ne_u32 vcc, 0, v32
    s_nop 3
    s_cmp_eq_u64 vcc, exec
    s_cbranch_scc1 L_h1go
    s_add_u32 s95, s95, 1
    s_cmp_lt_u32 s95, 16384
    s_cbranch_scc1 L_spf1_l
    s_branch L_h1go
L_s3:
    s_mov_b32 s95, 0
L_s3_l:
    s_sleep 6
    buffer_load_dwordx4 v[32:35], v29, s[16:19], 0 offen sc1
    s_waitcnt vmcnt(0)
    v_and_b32 v32, v32, v33
    v_and_b32 v34, v34, v35
    v_and_b32 v32, v32, v34
    v_cmp_ne_u32 vcc, 0, v32
    s_nop 3
    s_cmp_eq_u64 vcc, exec
    s_cbranch_scc1 L_c3
    s_add_u32 s95, s95, 1
    s_cmp_lt_u32 s95, 16384
    s_cbranch_scc1 L_s3_l
    s_branch L_c3
L_s6:
    s_mov_b32 s95, 0
L_s6_l:
    s_sleep 6
    buffer_load_dword v32, v28, s[16:19], 0 offen sc1
    s_waitcnt vmcnt(0)
    v_cmp_le_u32 vcc, 32, v32
    s_nop 3
    s_cmp_eq_u64 vcc, exec
    s_cbranch_scc1 L_c6
    s_add_u32 s95, s95, 1
    s_cmp_lt_u32 s95, 16384
    s_cbranch_scc1 L_s6_l
    s_branch L_c6
L_s9:
    s_mov_b32 s95, 0
L_s9_l:
    s_sleep 6
    buffer_load_dword v32, v17, s[16:19], s28 offen offset:2048 sc1
    s_waitcnt vmcnt(0)
    v_readfirstlane_b32 s93, v32
    s_cmp_ge_u32 s93, 32
    s_cbranch_scc1 L_c9
    s_add_u32 s95, s95, 1
    s_cmp_lt_u32 s95, 16384
    s_cbranch_scc1 L_s9_l
    s_branch L_c9
L_spin0:
    s_mov_b32 s95, 0
L_spin0_l:
    s_sleep 6
    buffer_load_dword v32, v17, s[16:19], s28 offen offset:0 sc1
    s_waitcnt vmcnt(0)
    v_readfirstlane_b32 s93, v32
    s_cmp_ge_u32 s93, 32
    s_cbranch_scc1 L_go0
    s_add_u32 s95, s95, 1
    s_cmp_lt_u32 s95, 16384
    s_cbranch_scc1 L_spin0_l
    s_branch L_go0
L_codeend:
L_fbA:
    s_waitcnt vmcnt(0) lgkmcnt(0)
    s_max_u32 s34, s41, 8
    s_sub_u32 s34, s34, 8
    s_add_u32 s35, s41, 1
    v_mov_b32 v15, 0
    v_mov_b32 v5, v11
    s_mov_b32 s94, s34
L_fbA_p0:
    s_lshl_b32 s93, s94, 12
    s_add_u32 s93, s93, s42
    buffer_load_dwordx4 v[52:55], v6, s[16:19], s93 offen sc1
    buffer_load_dwordx4 v[56:59], v6, s[16:19], s93 offen offset:1024 sc1
    s_sub_u32 s93, s41, s94
    s_lshl_b32 s93, s93, 5
    v_add_u32 v4, s93, v10
    v_subrev_u32 v132, 0, v4
    v_subrev_u32 v133, 1, v4
    v_subrev_u32 v134, 2, v4
    v_subrev_u32 v135, 3, v4
    v_cmp_gt_u32 s[60:61], s50, v132
    v_cmp_gt_u32 s[62:63], s50, v133
    v_cmp_gt_u32 s[64:65], s50, v134
    v_cmp_gt_u32 s[66:67], s50, v135
    s_nop 1
    v_cndmask_b32 v132, v11, v15, s[60:61]
    v_cndmask_b32 v133, v11, v15, s[62:63]
    v_cndmask_b32 v134, v11, v15, s[64:65]
    v_cndmask_b32 v135, v11, v15, s[66:67]
    v_subrev_u32 v136, 16, v4
    v_subrev_u32 v137, 17, v4
    v_subrev_u32 v138, 18, v4
    v_subrev_u32 v139, 19, v4
    v_cmp_gt_u32 s[60:61], s50, v136
    v_cmp_gt_u32 s[62:63], s50, v137
    v_cmp_gt_u32 s[64:65], s50, v138
    v_cmp_gt_u32 s[66:67], s50, v139
    s_nop 1
    v_cndmask_b32 v136, v11, v15, s[60:61]
    v_cndmask_b32 v137, v11, v15, s[62:63]
    v_cndmask_b32 v138, v11, v15, s[64:65]
    v_cndmask_b32 v139, v11, v15, s[66:67]
    v_subrev_u32 v140, 8, v4
    v_subrev_u32 v141, 9, v4
    v_subrev_u32 v142, 10, v4
    v_subrev_u32 v143, 11, v4
    v_cmp_gt_u32 s[60:61], s50, v140
    v_cmp_gt_u32 s[62:63], s50, v141
    v_cmp_gt_u32 s[64:65], s50, v142
    v_cmp_gt_u32 s[66:67], s50, v143
    s_nop 1
    v_cndmask_b32 v140, v11, v15, s[60:61]
    v_cndmask_b32 v141, v11, v15, s[62:63]
    v_cndmask_b32 v142, v11, v15, s[64:65]
    v_cndmask_b32 v143, v11, v15, s[66:67]
    v_subrev_u32 v144, 24, v4
    v_subrev_u32 v145, 25, v4
    v_subrev_u32 v146, 26, v4
    v_subrev_u32 v147, 27, v4
    v_cmp_gt_u32 s[60:61], s50, v144
    v_cmp_gt_u32 s[62:63], s50, v145
    v_cmp_gt_u32 s[64:65], s50, v146
    v_cmp_gt_u32 s[66:67], s50, v147
    s_nop 1
    v_cndmask_b32 v144, v11, v15, s[60:61]
    v_cndmask_b32 v145, v11, v15, s[62:63]
    v_cndmask_b32 v146, v11, v15, s[64:65]
    v_cndmask_b32 v147, v11, v15, s[66:67]
    s_waitcnt vmcnt(0)
    s_nop 1
    v_mfma_f32_32x32x16_bf16 v[116:131], v[52:55], v[200:203], v[132:147]
    v_mfma_f32_32x32x16_bf16 v[116:131], v[56:59], v[204:207], v[116:131]
    s_nop 15
    s_nop 3
    v_max3_f32 v5, v5, v116, v117
    v_max3_f32 v5, v5, v118, v119
    v_max3_f32 v5, v5, v120, v121
    v_max3_f32 v5, v5, v122, v123
    v_max3_f32 v5, v5, v124, v125
    v_max3_f32 v5, v5, v126, v127
    v_max3_f32 v5, v5, v128, v129
    v_max3_f32 v5, v5, v130, v131
    s_add_u32 s94, s94, 1
    s_cmp_lt_u32 s94, s35
    s_cbranch_scc1 L_fbA_p0
    v_mov_b32 v4, v5
    s_nop 1
    v_permlane32_swap_b32 v4, v5
    s_nop 1
    v_max_f32 v4, v4, v5
    v_sub_f32 v15, 0, v4
    v_mov_b32 v216, 0
    v_mov_b32 v217, 0
    v_mov_b32 v218, 0
    v_mov_b32 v219, 0
    v_mov_b32 v220, 0
    v_mov_b32 v221, 0
    v_mov_b32 v222, 0
    v_mov_b32 v223, 0
    v_mov_b32 v224, 0
    v_mov_b32 v225, 0
    v_mov_b32 v226, 0
    v_mov_b32 v227, 0
    v_mov_b32 v228, 0
    v_mov_b32 v229, 0
    v_mov_b32 v230, 0
    v_mov_b32 v231, 0
    v_mov_b32 v232, 0
    v_mov_b32 v233, 0
    v_mov_b32 v234, 0
    v_mov_b32 v235, 0
    s_mov_b32 s94, s34
L_fbA_p1:
    s_lshl_b32 s93, s94, 12
    s_add_u32 s93, s93, s42
    buffer_load_dwordx4 v[52:55], v6, s[16:19], s93 offen sc1
    buffer_load_dwordx4 v[56:59], v6, s[16:19], s93 offen offset:1024 sc1
    buffer_load_dwordx4 v[68:71], v6, s[16:19], s93 offen offset:2048 sc1
    buffer_load_dwordx4 v[72:75], v6, s[16:19], s93 offen offset:3072 sc1
    s_sub_u32 s93, s41, s94
    s_lshl_b32 s93, s93, 5
    v_add_u32 v4, s93, v10
    v_subrev_u32 v132, 0, v4
    v_subrev_u32 v133, 1, v4
    v_subrev_u32 v134, 2, v4
    v_subrev_u32 v135, 3, v4
    v_cmp_gt_u32 s[60:61], s50, v132
    v_cmp_gt_u32 s[62:63], s50, v133
    v_cmp_gt_u32 s[64:65], s50, v134
    v_cmp_gt_u32 s[66:67], s50, v135
    s_nop 1
    v_cndmask_b32 v132, v11, v15, s[60:61]
    v_cndmask_b32 v133, v11, v15, s[62:63]
    v_cndmask_b32 v134, v11, v15, s[64:65]
    v_cndmask_b32 v135, v11, v15, s[66:67]
    v_subrev_u32 v136, 16, v4
    v_subrev_u32 v137, 17, v4
    v_subrev_u32 v138, 18, v4
    v_subrev_u32 v139, 19, v4
    v_cmp_gt_u32 s[60:61], s50, v136
    v_cmp_gt_u32 s[62:63], s50, v137
    v_cmp_gt_u32 s[64:65], s50, v138
    v_cmp_gt_u32 s[66:67], s50, v139
    s_nop 1
    v_cndmask_b32 v136, v11, v15, s[60:61]
    v_cndmask_b32 v137, v11, v15, s[62:63]
    v_cndmask_b32 v138, v11, v15, s[64:65]
    v_cndmask_b32 v139, v11, v15, s[66:67]
    v_subrev_u32 v140, 8, v4
    v_subrev_u32 v141, 9, v4
    v_subrev_u32 v142, 10, v4
    v_subrev_u32 v143, 11, v4
    v_cmp_gt_u32 s[60:61], s50, v140
    v_cmp_gt_u32 s[62:63], s50, v141
    v_cmp_gt_u32 s[64:65], s50, v142
    v_cmp_gt_u32 s[66:67], s50, v143
    s_nop 1
    v_cndmask_b32 v140, v11, v15, s[60:61]
    v_cndmask_b32 v141, v11, v15, s[62:63]
    v_cndmask_b32 v142, v11, v15, s[64:65]
    v_cndmask_b32 v143, v11, v15, s[66:67]
    v_subrev_u32 v144, 24, v4
    v_subrev_u32 v145, 25, v4
    v_subrev_u32 v146, 26, v4
    v_subrev_u32 v147, 27, v4
    v_cmp_gt_u32 s[60:61], s50, v144
    v_cmp_gt_u32 s[62:63], s50, v145
    v_cmp_gt_u32 s[64:65], s50, v146
    v_cmp_gt_u32 s[66:67], s50, v147
    s_nop 1
    v_cndmask_b32 v144, v11, v15, s[60:61]
    v_cndmask_b32 v145, v11, v15, s[62:63]
    v_cndmask_b32 v146, v11, v15, s[64:65]
    v_cndmask_b32 v147, v11, v15, s[66:67]
    s_waitcnt vmcnt(0)
    s_nop 1
    v_mfma_f32_32x32x16_bf16 v[116:131], v[52:55], v[200:203], v[132:147]
    v_mfma_f32_32x32x16_bf16 v[116:131], v[56:59], v[204:207], v[116:131]
    s_nop 15
    s_nop 3
    v_exp_f32 v116, v116
    v_exp_f32 v117, v117
    v_exp_f32 v118, v118
    v_exp_f32 v119, v119
    v_exp_f32 v120, v120
    v_exp_f32 v121, v121
    v_exp_f32 v122, v122
    v_exp_f32 v123, v123
    v_exp_f32 v124, v124
    v_exp_f32 v125, v125
    v_exp_f32 v126, v126
    v_exp_f32 v127, v127
    v_exp_f32 v128, v128
    v_exp_f32 v129, v129
    v_exp_f32 v130, v130
    v_exp_f32 v131, v131
    s_nop 0
    v_cvt_pk_bf16_f32 v84, v116, v117
    v_cvt_pk_bf16_f32 v85, v118, v119
    v_cvt_pk_bf16_f32 v86, v120, v121
    v_cvt_pk_bf16_f32 v87, v122, v123
    v_cvt_pk_bf16_f32 v88, v124, v125
    v_cvt_pk_bf16_f32 v89, v126, v127
    v_cvt_pk_bf16_f32 v90, v128, v129
    v_cvt_pk_bf16_f32 v91, v130, v131
    s_nop 1
    v_mfma_f32_32x32x16_bf16 v[216:231], v[68:71], v[84:87], v[216:231]
    v_mfma_f32_32x32x16_bf16 v[216:231], v[72:75], v[88:91], v[216:231]
    v_smfmac_f32_16x16x64_bf16 v[232:235], v[92:95], v[84:91], v16
    s_nop 7
    s_add_u32 s94, s94, 1
    s_cmp_lt_u32 s94, s35
    s_cbranch_scc1 L_fbA_p1
    s_nop 15
    s_nop 3
    v_add_f32 v232, v232, v233
    s_branch L_stA
L_fbB:
    s_waitcnt vmcnt(0) lgkmcnt(0)
    s_mov_b32 s34, 0
    s_mov_b32 s35, 64
    v_mov_b32 v15, 0
    v_mov_b32 v5, v11
    s_mov_b32 s94, s34
L_fbB_p0:
    s_lshl_b32 s93, s94, 12
    s_add_u32 s93, s93, s43
    buffer_load_dwordx4 v[52:55], v6, s[16:19], s93 offen sc1
    buffer_load_dwordx4 v[56:59], v6, s[16:19], s93 offen offset:1024 sc1
    v_mov_b32 v132, v15
    v_mov_b32 v133, v15
    v_mov_b32 v134, v15
    v_mov_b32 v135, v15
    v_mov_b32 v136, v15
    v_mov_b32 v137, v15
    v_mov_b32 v138, v15
    v_mov_b32 v139, v15
    v_mov_b32 v140, v15
    v_mov_b32 v141, v15
    v_mov_b32 v142, v15
    v_mov_b32 v143, v15
    v_mov_b32 v144, v15
    v_mov_b32 v145, v15
    v_mov_b32 v146, v15
    v_mov_b32 v147, v15
    s_waitcnt vmcnt(0)
    s_nop 1
    v_mfma_f32_32x32x16_bf16 v[116:131], v[52:55], v[36:39], v[132:147]
    v_mfma_f32_32x32x16_bf16 v[116:131], v[56:59], v[40:43], v[116:131]
    s_nop 15
    s_nop 3
    v_max3_f32 v5, v5, v116, v117
    v_max3_f32 v5, v5, v118, v119
    v_max3_f32 v5, v5, v120, v121
    v_max3_f32 v5, v5, v122, v123
    v_max3_f32 v5, v5, v124, v125
    v_max3_f32 v5, v5, v126, v127
    v_max3_f32 v5, v5, v128, v129
    v_max3_f32 v5, v5, v130, v131
    s_add_u32 s94, s94, 1
    s_cmp_lt_u32 s94, s35
    s_cbranch_scc1 L_fbB_p0
    v_mov_b32 v4, v5
    s_nop 1
    v_permlane32_swap_b32 v4, v5
    s_nop 1
    v_max_f32 v4, v4, v5
    v_sub_f32 v15, 0, v4
    v_mov_b32 v100, 0
    v_mov_b32 v101, 0
    v_mov_b32 v102, 0
    v_mov_b32 v103, 0
    v_mov_b32 v104, 0
    v_mov_b32 v105, 0
    v_mov_b32 v106, 0
    v_mov_b32 v107, 0
    v_mov_b32 v108, 0
    v_mov_b32 v109, 0
    v_mov_b32 v110, 0
    v_mov_b32 v111, 0
    v_mov_b32 v112, 0
    v_mov_b32 v113, 0
    v_mov_b32 v114, 0
    v_mov_b32 v115, 0
    v_mov_b32 v96, 0
    v_mov_b32 v97, 0
    v_mov_b32 v98, 0
    v_mov_b32 v99, 0
    s_mov_b32 s94, s34
L_fbB_p1:
    s_lshl_b32 s93, s94, 12
    s_add_u32 s93, s93, s43
    buffer_load_dwordx4 v[52:55], v6, s[16:19], s93 offen sc1
    buffer_load_dwordx4 v[56:59], v6, s[16:19], s93 offen offset:1024 sc1
    buffer_load_dwordx4 v[68:71], v6, s[16:19], s93 offen offset:2048 sc1
    buffer_load_dwordx4 v[72:75], v6, s[16:19], s93 offen offset:3072 sc1
    v_mov_b32 v132, v15
    v_mov_b32 v133, v15
    v_mov_b32 v134, v15
    v_mov_b32 v135, v15
    v_mov_b32 v136, v15
    v_mov_b32 v137, v15
    v_mov_b32 v138, v15
    v_mov_b32 v139, v15
    v_mov_b32 v140, v15
    v_mov_b32 v141, v15
    v_mov_b32 v142, v15
    v_mov_b32 v143, v15
    v_mov_b32 v144, v15
    v_mov_b32 v145, v15
    v_mov_b32 v146, v15
    v_mov_b32 v147, v15
    s_waitcnt vmcnt(0)
    s_nop 1
    v_mfma_f32_32x32x16_bf16 v[116:131], v[52:55], v[36:39], v[132:147]
    v_mfma_f32_32x32x16_bf16 v[116:131], v[56:59], v[40:43], v[116:131]
    s_nop 15
    s_nop 3
    v_exp_f32 v116, v116
    v_exp_f32 v117, v117
    v_exp_f32 v118, v118
    v_exp_f32 v119, v119
    v_exp_f32 v120, v120
    v_exp_f32 v121, v121
    v_exp_f32 v122, v122
    v_exp_f32 v123, v123
    v_exp_f32 v124, v124
    v_exp_f32 v125, v125
    v_exp_f32 v126, v126
    v_exp_f32 v127, v127
    v_exp_f32 v128, v128
    v_exp_f32 v129, v129
    v_exp_f32 v130, v130
    v_exp_f32 v131, v131
    s_nop 0
    v_cvt_pk_bf16_f32 v84, v116, v117
    v_cvt_pk_bf16_f32 v85, v118, v119
    v_cvt_pk_bf16_f32 v86, v120, v121
    v_cvt_pk_bf16_f32 v87, v122, v123
    v_cvt_pk_bf16_f32 v88, v124, v125
    v_cvt_pk_bf16_f32 v89, v126, v127
    v_cvt_pk_bf16_f32 v90, v128, v129
    v_cvt_pk_bf16_f32 v91, v130, v131
    s_nop 1
    v_mfma_f32_32x32x16_bf16 v[100:115], v[68:71], v[84:87], v[100:115]
    v_mfma_f32_32x32x16_bf16 v[100:115], v[72:75], v[88:91], v[100:115]
    v_smfmac_f32_16x16x64_bf16 v[96:99], v[92:95], v[84:91], v16
    s_nop 7
    s_add_u32 s94, s94, 1
    s_cmp_lt_u32 s94, s35
    s_cbranch_scc1 L_fbB_p1
    s_nop 15
    s_nop 3
    v_add_f32 v96, v96, v97
    s_branch L_stB
.section .rodata,"a"
.p2align 6
.amdhsa_kernel gated_mix__sliding_block__mha_block__prompt_kernel
  .amdhsa_next_free_vgpr 254
  .amdhsa_next_free_sgpr 102
  .amdhsa_accum_offset 256
  .amdhsa_group_segment_fixed_size 0
  .amdhsa_kernarg_size 80
  .amdhsa_user_sgpr_count 2
  .amdhsa_user_sgpr_kernarg_segment_ptr 1
  .amdhsa_system_sgpr_workgroup_id_x 1
.end_amdhsa_kernel
```
